```python
import torch

def _softmax(x, axis=-1):
    return torch.softmax(x, dim=axis)
def _gelu(x):
    return torch.nn.functional.gelu(x, approximate="tanh")
def _silu(x):
    return torch.nn.functional.silu(x)
def _sigmoid(x):
    return torch.sigmoid(x)
def _layernorm(x, axis=-1, eps=1e-5):
    m = x.mean(dim=axis, keepdim=True)
    v = x.var(dim=axis, keepdim=True, unbiased=False)
    return (x - m) / torch.sqrt(v + eps)
def _scatter_add(tgt, idx, src, axis=0):
    return tgt.clone().index_add_(axis, idx, src)
def _segment_sum(src, seg, n):
    out = torch.zeros((n,) + src.shape[1:], dtype=src.dtype)
    return out.index_add_(0, seg, src)
def _pad(x, pw):
    flat = tuple(v for pair in reversed(pw) for v in pair)
    return torch.nn.functional.pad(x, flat)

kernel_name = 'parallel_sum__mha_block__dense_activation_gelu__prompt'

def setup_inputs():

    _w = (lambda a: (lambda t: t.to(torch.bfloat16) if t.is_floating_point() else t)(torch.as_tensor(a)))
    def _A_setup():
        B, S, D, H = 1, 2048, 448, 16
        return {
            "x": _w((lambda *s: torch.randn(*s, dtype=torch.bfloat16) * 0.05)(B, S, D)),
            "wqkv": _w((lambda *s: torch.randn(*s, dtype=torch.bfloat16) * 0.05)(D, 3 * D)),
            "wo": _w((lambda *s: torch.randn(*s, dtype=torch.bfloat16) * 0.05)(D, D)),
        }
    _A_in = _A_setup()

    def _B_setup():
        B, S, D, F = 1, 2048, 448, 1792
        return {
            "x": _w((lambda *s: torch.randn(*s, dtype=torch.bfloat16) * 0.05)(B, S, D)),
            "w1": _w((lambda *s: torch.randn(*s, dtype=torch.bfloat16) * 0.8)(D, F) * (D ** -0.5)),
            "b1": _w((lambda *s: torch.randn(*s, dtype=torch.bfloat16) * 12.8)(F) * 0.01),
            "w2": _w((lambda *s: torch.randn(*s, dtype=torch.bfloat16) * 0.4)(F, D) * (F ** -0.5)),
            "b2": _w((lambda *s: torch.randn(*s, dtype=torch.bfloat16) * 6.4)(D) * 0.01),
        }
    _B_in = _B_setup()

    return {
        "A_x": _A_in["x"],
        "A_wqkv": _A_in["wqkv"],
        "A_wo": _A_in["wo"],
        "B_x": _B_in["x"],
        "B_w1": _B_in["w1"],
        "B_b1": _B_in["b1"],
        "B_w2": _B_in["w2"],
        "B_b2": _B_in["b2"],
    }

def reference(A_x, A_wqkv, A_wo, B_x, B_w1, B_b1, B_w2, B_b2):
    def _A_ref(x, wqkv, wo):
        B, S, D = x.shape
        H = 16
        Dh = D // H
        qkv = (lambda x, *d: x.permute(*d))((x @ wqkv).reshape(B, S, 3, H, Dh), 2, 0, 3, 1, 4)
        q, k, v = qkv[0], qkv[1], qkv[2]
        scores = torch.einsum("bhqd,bhkd->bhqk", q, k) * (Dh ** -0.5)
        p = _softmax(scores, axis=-1)
        o = torch.einsum("bhqk,bhkd->bhqd", p, v)
        return (lambda x, *d: x.permute(*d))(o, 0, 2, 1, 3).reshape(B, S, D) @ wo

    def _B_ref(x, w1, b1, w2, b2):
        h = torch.einsum("bsd,df->bsf", x, w1) + b1
        h = _gelu(h)
        return torch.einsum("bsf,fd->bsd", h, w2) + b2

    x = A_x
    xn = _layernorm(x, axis=-1)
    return x + _A_ref(xn, A_wqkv, A_wo) + _B_ref(xn, B_w1, B_b1, B_w2, B_b2)
```

```asm
; @launch grid=(256,1,1) block=(512,1,1) lds=163840
.amdgcn_target "amdgcn-amd-amdhsa--gfx950"
.text
.globl parallel_sum__mha_block__dense_activation_gelu__prompt_kernel
.p2align 8
.type parallel_sum__mha_block__dense_activation_gelu__prompt_kernel,@function
parallel_sum__mha_block__dense_activation_gelu__prompt_kernel:
    s_cmp_ge_u32 s2, 256
    s_cbranch_scc1 K_END
    s_load_dwordx4 s[36:39], s[0:1], 0
    s_load_dwordx2 s[40:41], s[0:1], 16
    s_load_dwordx8 s[44:51], s[0:1], 32
    s_load_dwordx2 s[52:53], s[0:1], 64
    s_load_dwordx2 s[54:55], s[0:1], 80
    s_and_b32 s23, s2, 7
    s_lshr_b32 s24, s2, 3
    s_and_b32 s20, s23, 1
    s_lshl_b32 s20, s20, 3
    s_and_b32 s25, s24, 7
    s_add_u32 s20, s20, s25
    s_lshr_b32 s21, s23, 1
    s_lshl_b32 s21, s21, 2
    s_lshr_b32 s25, s24, 3
    s_add_u32 s21, s21, s25
    v_lshrrev_b32 v2, 6, v0
    v_and_b32 v1, 63, v0
    v_readfirstlane_b32 s3, v2
    v_lshlrev_b32 v6, 4, v1
    s_and_b32 s22, s3, 3
    s_lshr_b32 s26, s3, 2
    v_lshrrev_b32 v5, 3, v1
    v_mul_u32_u24 v5, 896, v5
    v_and_b32 v9, 7, v1
    v_lshrrev_b32 v10, 4, v1
    v_xor_b32 v9, v9, v10
    v_lshl_add_u32 v3, v9, 4, v5
    v_xor_b32 v9, 4, v9
    v_lshl_add_u32 v4, v9, 4, v5
    v_lshrrev_b32 v9, 2, v1
    v_and_b32 v10, 3, v1
    v_lshlrev_b32 v10, 4, v10
    v_mul_u32_u24 v5, 2688, v9
    v_add_u32 v5, v5, v10
    v_mul_u32_u24 v7, 3584, v9
    v_add_u32 v7, v7, v10
    v_mov_b32 v24, 0x7fffff00
    v_cmp_gt_u32 vcc, 56, v1
    s_nop 1
    v_cndmask_b32 v24, v24, v6, vcc
    s_mul_i32 s28, s21, 168
    s_lshr_b32 s32, s21, 1
    s_mul_i32 s32, s32, 7
    s_and_b32 s33, s21, 1
    s_lshl_b32 s33, s33, 2
    s_add_u32 s33, s33, s32
    s_lshl_b32 s60, s33, 6
    s_add_u32 s61, s60, 64
    s_add_u32 s62, s60, 128
    s_add_u32 s63, s32, 3
    s_lshl_b32 s63, s63, 6
    s_lshl_b32 s24, s20, 7
    s_lshl_b32 s25, s22, 5
    s_add_u32 s24, s24, s25
    s_mul_i32 s24, s24, 896
    s_lshl_b32 s27, s22, 12
    s_and_b32 s64, s28, 0xffffffc0
    s_lshl_b32 s57, s22, 6
    s_add_u32 s64, s64, s57
    s_lshl_b32 s34, s22, 12
    s_lshl_b32 s96, s3, 11
    s_lshl_b32 s97, s20, 7
    s_lshl_b32 s57, s3, 4
    s_add_u32 s97, s97, s57
    s_mul_i32 s97, s97, 896
    s_lshl_b32 s98, s22, 12
    s_lshl_b32 s57, s26, 11
    s_add_u32 s98, s98, s57
    s_mul_i32 s57, s26, 86016
    s_add_u32 s99, s64, s57
    s_mul_i32 s66, s22, 401408
    s_mul_i32 s35, s22, 7168
    s_mov_b32 s68, s60
    s_cmp_eq_u32 s22, 1
    s_cselect_b32 s68, s61, s68
    s_cmp_eq_u32 s22, 2
    s_cselect_b32 s68, s62, s68
    s_cmp_eq_u32 s22, 3
    s_cselect_b32 s68, s63, s68
    v_lshrrev_b32 v9, 4, v1
    v_and_b32 v10, 15, v1
    v_lshlrev_b32 v10, 2, v10
    v_mul_u32_u24 v25, 18816, v9
    v_add_u32 v25, v25, v10
    v_mul_u32_u24 v26, 25088, v9
    v_add_u32 v26, v26, v10
    s_waitcnt lgkmcnt(0)
    s_mov_b32 s4, s36
    s_and_b32 s5, s37, 0xffff
    s_mov_b32 s6, 1835008
    s_mov_b32 s7, 0x20000
    s_mov_b32 s8, s38
    s_and_b32 s9, s39, 0xffff
    s_mov_b32 s10, 1204224
    s_mov_b32 s11, 0x20000
    s_mov_b32 s16, s44
    s_and_b32 s17, s45, 0xffff
    s_mov_b32 s18, 1605632
    s_mov_b32 s19, 0x20000
    s_mov_b32 s12, s54
    s_and_b32 s13, s55, 0xffff
    s_mov_b32 s14, 17825792
    s_mov_b32 s15, 0x20000
    s_mov_b32 s76, s46
    s_and_b32 s77, s47, 0xffff
    s_mov_b32 s78, 3584
    s_mov_b32 s79, 0x20000
    s_add_u32 s58, s54, 17334272
    s_addc_u32 s59, s55, 0
    s_load_dword s56, s[58:59], 0
    s_cmp_ge_u32 s3, 4
    s_cbranch_scc1 AB_B
    s_add_u32 m0, s27, 32768
    s_add_u32 s57, s24, 0
    buffer_load_dwordx4 v3, s[4:7], s57 offen lds
    s_add_u32 m0, s27, 33792
    s_add_u32 s57, s24, 7168
    buffer_load_dwordx4 v4, s[4:7], s57 offen lds
    s_add_u32 m0, s27, 34816
    s_add_u32 s57, s24, 14336
    buffer_load_dwordx4 v3, s[4:7], s57 offen lds
    s_add_u32 m0, s27, 35840
    s_add_u32 s57, s24, 21504
    buffer_load_dwordx4 v4, s[4:7], s57 offen lds
    s_add_u32 m0, s34, 49152
    s_add_u32 s57, s64, 0
    buffer_load_dwordx4 v5, s[8:11], s57 offen lds
    s_add_u32 m0, s34, 50176
    s_add_u32 s57, s64, 43008
    buffer_load_dwordx4 v5, s[8:11], s57 offen lds
    s_add_u32 m0, s34, 51200
    s_add_u32 s57, s64, 86016
    buffer_load_dwordx4 v5, s[8:11], s57 offen lds
    s_add_u32 m0, s34, 52224
    s_add_u32 s57, s64, 129024
    buffer_load_dwordx4 v5, s[8:11], s57 offen lds
    s_barrier
    s_add_u32 m0, s27, 65536
    s_add_u32 s57, s24, 128
    buffer_load_dwordx4 v3, s[4:7], s57 offen lds
    s_add_u32 m0, s27, 66560
    s_add_u32 s57, s24, 7296
    buffer_load_dwordx4 v4, s[4:7], s57 offen lds
    s_add_u32 m0, s27, 67584
    s_add_u32 s57, s24, 14464
    buffer_load_dwordx4 v3, s[4:7], s57 offen lds
    s_add_u32 m0, s27, 68608
    s_add_u32 s57, s24, 21632
    buffer_load_dwordx4 v4, s[4:7], s57 offen lds
    s_add_u32 m0, s34, 81920
    s_add_u32 s57, s64, 172032
    buffer_load_dwordx4 v5, s[8:11], s57 offen lds
    s_add_u32 m0, s34, 82944
    s_add_u32 s57, s64, 215040
    buffer_load_dwordx4 v5, s[8:11], s57 offen lds
    s_add_u32 m0, s34, 83968
    s_add_u32 s57, s64, 258048
    buffer_load_dwordx4 v5, s[8:11], s57 offen lds
    s_add_u32 m0, s34, 84992
    s_add_u32 s57, s64, 301056
    buffer_load_dwordx4 v5, s[8:11], s57 offen lds
    s_add_u32 m0, s27, 98304
    s_add_u32 s57, s24, 256
    buffer_load_dwordx4 v3, s[4:7], s57 offen lds
    s_add_u32 m0, s27, 99328
    s_add_u32 s57, s24, 7424
    buffer_load_dwordx4 v4, s[4:7], s57 offen lds
    s_add_u32 m0, s27, 100352
    s_add_u32 s57, s24, 14592
    buffer_load_dwordx4 v3, s[4:7], s57 offen lds
    s_add_u32 m0, s27, 101376
    s_add_u32 s57, s24, 21760
    buffer_load_dwordx4 v4, s[4:7], s57 offen lds
    s_add_u32 m0, s34, 114688
    s_add_u32 s57, s64, 344064
    buffer_load_dwordx4 v5, s[8:11], s57 offen lds
    s_add_u32 m0, s34, 115712
    s_add_u32 s57, s64, 387072
    buffer_load_dwordx4 v5, s[8:11], s57 offen lds
    s_add_u32 m0, s34, 116736
    s_add_u32 s57, s64, 430080
    buffer_load_dwordx4 v5, s[8:11], s57 offen lds
    s_add_u32 m0, s34, 117760
    s_add_u32 s57, s64, 473088
    buffer_load_dwordx4 v5, s[8:11], s57 offen lds
    s_add_u32 m0, s27, 131072
    s_add_u32 s57, s24, 384
    buffer_load_dwordx4 v3, s[4:7], s57 offen lds
    s_add_u32 m0, s27, 132096
    s_add_u32 s57, s24, 7552
    buffer_load_dwordx4 v4, s[4:7], s57 offen lds
    s_add_u32 m0, s27, 133120
    s_add_u32 s57, s24, 14720
    buffer_load_dwordx4 v3, s[4:7], s57 offen lds
    s_add_u32 m0, s27, 134144
    s_add_u32 s57, s24, 21888
    buffer_load_dwordx4 v4, s[4:7], s57 offen lds
    s_add_u32 m0, s34, 147456
    s_add_u32 s57, s64, 516096
    buffer_load_dwordx4 v5, s[8:11], s57 offen lds
    s_add_u32 m0, s34, 148480
    s_add_u32 s57, s64, 559104
    buffer_load_dwordx4 v5, s[8:11], s57 offen lds
    s_add_u32 m0, s34, 149504
    s_add_u32 s57, s64, 602112
    buffer_load_dwordx4 v5, s[8:11], s57 offen lds
    s_add_u32 m0, s34, 150528
    s_add_u32 s57, s64, 645120
    buffer_load_dwordx4 v5, s[8:11], s57 offen lds
    v_and_b32 v9, 31, v1
    s_lshl_b32 s57, s22, 5
    v_add_u32 v9, s57, v9
    v_bfe_u32 v10, v9, 1, 3
    v_lshrrev_b32 v11, 5, v1
    v_xor_b32 v10, v10, v11
    v_lshlrev_b32 v27, 7, v9
    v_mov_b32 v24, v10
    v_xor_b32 v25, 0, v24
    v_lshl_add_u32 v8, v25, 4, v27
    v_add_u32 v8, 0x8000, v8
    v_add_u32 v12, 0x10000, v8
    v_xor_b32 v25, 2, v24
    v_lshl_add_u32 v9, v25, 4, v27
    v_add_u32 v9, 0x8000, v9
    v_add_u32 v13, 0x10000, v9
    v_xor_b32 v25, 4, v24
    v_lshl_add_u32 v10, v25, 4, v27
    v_add_u32 v10, 0x8000, v10
    v_add_u32 v14, 0x10000, v10
    v_xor_b32 v25, 6, v24
    v_lshl_add_u32 v11, v25, 4, v27
    v_add_u32 v11, 0x8000, v11
    v_add_u32 v15, 0x10000, v11
    v_lshrrev_b32 v20, 5, v1
    v_lshlrev_b32 v20, 9, v20
    v_bfe_u32 v25, v1, 2, 2
    v_lshl_add_u32 v20, v25, 6, v20
    v_bfe_u32 v25, v1, 4, 1
    v_lshl_add_u32 v20, v25, 5, v20
    v_and_b32 v25, 3, v1
    v_lshl_add_u32 v20, v25, 3, v20
    v_add_u32 v21, 0x10000, v20
    v_add_u32 v22, 0x10000, v21
    s_and_b32 s57, s28, 63
    v_bfe_u32 v24, v1, 4, 1
    v_lshlrev_b32 v24, 5, v24
    v_and_b32 v25, 3, v1
    v_lshl_add_u32 v24, v25, 3, v24
    v_add_u32 v24, s57, v24
    v_lshrrev_b32 v25, 5, v1
    v_lshlrev_b32 v25, 9, v25
    v_bfe_u32 v26, v1, 2, 2
    v_lshl_add_u32 v25, v26, 6, v25
    s_mov_b32 s37, 0
    v_add_u32 v26, 0, v24
    v_lshrrev_b32 v27, 6, v26
    v_lshlrev_b32 v27, 12, v27
    v_and_b32 v26, 63, v26
    v_add3_u32 v16, v27, v26, v25
    v_add_u32 v16, 49152, v16
    v_add_u32 v240, 0x10000, v16
    s_mov_b32 s38, 1
    v_add_u32 v26, 56, v24
    v_lshrrev_b32 v27, 6, v26
    v_lshlrev_b32 v27, 12, v27
    v_and_b32 v26, 63, v26
    v_add3_u32 v17, v27, v26, v25
    v_add_u32 v17, 49152, v17
    v_add_u32 v241, 0x10000, v17
    s_mov_b32 s39, 2
    v_add_u32 v26, 112, v24
    v_lshrrev_b32 v27, 6, v26
    v_lshlrev_b32 v27, 12, v27
    v_and_b32 v26, 63, v26
    v_add3_u32 v18, v27, v26, v25
    v_add_u32 v18, 49152, v18
    v_add_u32 v242, 0x10000, v18
    v_mov_b32 v80, 0
    v_mov_b32 v81, 0
    v_mov_b32 v82, 0
    v_mov_b32 v83, 0
    v_mov_b32 v84, 0
    v_mov_b32 v85, 0
    v_mov_b32 v86, 0
    v_mov_b32 v87, 0
    v_mov_b32 v88, 0
    v_mov_b32 v89, 0
    v_mov_b32 v90, 0
    v_mov_b32 v91, 0
    v_mov_b32 v92, 0
    v_mov_b32 v93, 0
    v_mov_b32 v94, 0
    v_mov_b32 v95, 0
    v_mov_b32 v96, 0
    v_mov_b32 v97, 0
    v_mov_b32 v98, 0
    v_mov_b32 v99, 0
    v_mov_b32 v100, 0
    v_mov_b32 v101, 0
    v_mov_b32 v102, 0
    v_mov_b32 v103, 0
    v_mov_b32 v104, 0
    v_mov_b32 v105, 0
    v_mov_b32 v106, 0
    v_mov_b32 v107, 0
    v_mov_b32 v108, 0
    v_mov_b32 v109, 0
    v_mov_b32 v110, 0
    v_mov_b32 v111, 0
    v_mov_b32 v112, 0
    v_mov_b32 v113, 0
    v_mov_b32 v114, 0
    v_mov_b32 v115, 0
    v_mov_b32 v116, 0
    v_mov_b32 v117, 0
    v_mov_b32 v118, 0
    v_mov_b32 v119, 0
    v_mov_b32 v120, 0
    v_mov_b32 v121, 0
    v_mov_b32 v122, 0
    v_mov_b32 v123, 0
    v_mov_b32 v124, 0
    v_mov_b32 v125, 0
    v_mov_b32 v126, 0
    v_mov_b32 v127, 0
    s_waitcnt lgkmcnt(0)
    s_add_u32 s56, s56, 1
    s_lshl_b32 s71, s20, 2
    s_add_u32 s71, s71, s22
    v_mov_b32 v36, 0x3f803f80
    v_and_b32 v25, 31, v1
    v_cmp_eq_u32 s[72:73], 28, v25
    s_waitcnt vmcnt(24)
    s_barrier
    ds_read_b128 v[128:131], v8 offset:0
    ds_read_b64_tr_b16 v[40:41], v16 offset:0
    ds_read_b64_tr_b16 v[42:43], v16 offset:256
    ds_read_b64_tr_b16 v[44:45], v17 offset:0
    ds_read_b64_tr_b16 v[46:47], v17 offset:256
    ds_read_b64_tr_b16 v[48:49], v18 offset:0
    ds_read_b64_tr_b16 v[50:51], v18 offset:256
    ds_read_b128 v[132:135], v9 offset:0
    ds_read_b64_tr_b16 v[52:53], v16 offset:1024
    ds_read_b64_tr_b16 v[54:55], v16 offset:1280
    ds_read_b64_tr_b16 v[56:57], v17 offset:1024
    ds_read_b64_tr_b16 v[58:59], v17 offset:1280
    ds_read_b64_tr_b16 v[60:61], v18 offset:1024
    ds_read_b64_tr_b16 v[62:63], v18 offset:1280
    ds_read_b128 v[136:139], v10 offset:0
    ds_read_b64_tr_b16 v[64:65], v16 offset:2048
    ds_read_b64_tr_b16 v[66:67], v16 offset:2304
    ds_read_b64_tr_b16 v[68:69], v17 offset:2048
    ds_read_b64_tr_b16 v[70:71], v17 offset:2304
    ds_read_b64_tr_b16 v[72:73], v18 offset:2048
    ds_read_b64_tr_b16 v[74:75], v18 offset:2304
    s_waitcnt lgkmcnt(14)
    v_cndmask_b32 v40, v40, v36, s[72:73]
    v_cndmask_b32 v41, v41, v36, s[72:73]
    v_cndmask_b32 v42, v42, v36, s[72:73]
    v_cndmask_b32 v43, v43, v36, s[72:73]
    v_mfma_f32_32x32x16_bf16 v[96:111], v[44:47], v[128:131], v[96:111]
    v_mfma_f32_32x32x16_bf16 v[112:127], v[48:51], v[128:131], v[112:127]
    v_mfma_f32_32x32x16_bf16 v[80:95], v[40:43], v[128:131], v[80:95]
    ds_read_b128 v[140:143], v11 offset:0
    ds_read_b64_tr_b16 v[40:41], v16 offset:3072
    ds_read_b64_tr_b16 v[42:43], v16 offset:3328
    ds_read_b64_tr_b16 v[44:45], v17 offset:3072
    ds_read_b64_tr_b16 v[46:47], v17 offset:3328
    ds_read_b64_tr_b16 v[48:49], v18 offset:3072
    ds_read_b64_tr_b16 v[50:51], v18 offset:3328
    s_waitcnt lgkmcnt(14)
    v_cndmask_b32 v52, v52, v36, s[72:73]
    v_cndmask_b32 v53, v53, v36, s[72:73]
    v_cndmask_b32 v54, v54, v36, s[72:73]
    v_cndmask_b32 v55, v55, v36, s[72:73]
    v_mfma_f32_32x32x16_bf16 v[96:111], v[56:59], v[132:135], v[96:111]
    v_mfma_f32_32x32x16_bf16 v[112:127], v[60:63], v[132:135], v[112:127]
    v_mfma_f32_32x32x16_bf16 v[80:95], v[52:55], v[132:135], v[80:95]
    s_waitcnt lgkmcnt(7)
    v_cndmask_b32 v64, v64, v36, s[72:73]
    v_cndmask_b32 v65, v65, v36, s[72:73]
    v_cndmask_b32 v66, v66, v36, s[72:73]
    v_cndmask_b32 v67, v67, v36, s[72:73]
    v_mfma_f32_32x32x16_bf16 v[96:111], v[68:71], v[136:139], v[96:111]
    v_mfma_f32_32x32x16_bf16 v[112:127], v[72:75], v[136:139], v[112:127]
    v_mfma_f32_32x32x16_bf16 v[80:95], v[64:67], v[136:139], v[80:95]
    s_waitcnt vmcnt(16) lgkmcnt(0)
    s_barrier
    ds_read_b128 v[144:147], v8 offset:32768
    ds_read_b64_tr_b16 v[52:53], v16 offset:32768
    ds_read_b64_tr_b16 v[54:55], v16 offset:33024
    ds_read_b64_tr_b16 v[56:57], v17 offset:32768
    ds_read_b64_tr_b16 v[58:59], v17 offset:33024
    ds_read_b64_tr_b16 v[60:61], v18 offset:32768
    ds_read_b64_tr_b16 v[62:63], v18 offset:33024
    ds_read_b128 v[148:151], v9 offset:32768
    ds_read_b64_tr_b16 v[64:65], v16 offset:33792
    ds_read_b64_tr_b16 v[66:67], v16 offset:34048
    ds_read_b64_tr_b16 v[68:69], v17 offset:33792
    ds_read_b64_tr_b16 v[70:71], v17 offset:34048
    ds_read_b64_tr_b16 v[72:73], v18 offset:33792
    ds_read_b64_tr_b16 v[74:75], v18 offset:34048
    v_cndmask_b32 v40, v40, v36, s[72:73]
    v_cndmask_b32 v41, v41, v36, s[72:73]
    v_cndmask_b32 v42, v42, v36, s[72:73]
    v_cndmask_b32 v43, v43, v36, s[72:73]
    v_mfma_f32_32x32x16_bf16 v[96:111], v[44:47], v[140:143], v[96:111]
    s_add_u32 m0, s96, 32768
    s_add_u32 s57, s97, 512
    buffer_load_dwordx4 v3, s[4:7], s57 offen lds
    v_mfma_f32_32x32x16_bf16 v[112:127], v[48:51], v[140:143], v[112:127]
    v_mfma_f32_32x32x16_bf16 v[80:95], v[40:43], v[140:143], v[80:95]
    ds_read_b128 v[152:155], v10 offset:32768
    ds_read_b64_tr_b16 v[40:41], v16 offset:34816
    ds_read_b64_tr_b16 v[42:43], v16 offset:35072
    ds_read_b64_tr_b16 v[44:45], v17 offset:34816
    ds_read_b64_tr_b16 v[46:47], v17 offset:35072
    ds_read_b64_tr_b16 v[48:49], v18 offset:34816
    ds_read_b64_tr_b16 v[50:51], v18 offset:35072
    s_waitcnt lgkmcnt(14)
    v_cndmask_b32 v52, v52, v36, s[72:73]
    v_cndmask_b32 v53, v53, v36, s[72:73]
    v_cndmask_b32 v54, v54, v36, s[72:73]
    v_cndmask_b32 v55, v55, v36, s[72:73]
    v_mfma_f32_32x32x16_bf16 v[96:111], v[56:59], v[144:147], v[96:111]
    s_add_u32 m0, s96, 33792
    s_add_u32 s57, s97, 7680
    buffer_load_dwordx4 v4, s[4:7], s57 offen lds
    v_mfma_f32_32x32x16_bf16 v[112:127], v[60:63], v[144:147], v[112:127]
    v_mfma_f32_32x32x16_bf16 v[80:95], v[52:55], v[144:147], v[80:95]
    ds_read_b128 v[156:159], v11 offset:32768
    ds_read_b64_tr_b16 v[52:53], v16 offset:35840
    ds_read_b64_tr_b16 v[54:55], v16 offset:36096
    ds_read_b64_tr_b16 v[56:57], v17 offset:35840
    ds_read_b64_tr_b16 v[58:59], v17 offset:36096
    ds_read_b64_tr_b16 v[60:61], v18 offset:35840
    ds_read_b64_tr_b16 v[62:63], v18 offset:36096
    s_waitcnt lgkmcnt(14)
    v_cndmask_b32 v64, v64, v36, s[72:73]
    v_cndmask_b32 v65, v65, v36, s[72:73]
    v_cndmask_b32 v66, v66, v36, s[72:73]
    v_cndmask_b32 v67, v67, v36, s[72:73]
    v_mfma_f32_32x32x16_bf16 v[96:111], v[68:71], v[148:151], v[96:111]
    s_add_u32 m0, s98, 49152
    s_add_u32 s57, s99, 688128
    buffer_load_dwordx4 v5, s[8:11], s57 offen lds
    v_mfma_f32_32x32x16_bf16 v[112:127], v[72:75], v[148:151], v[112:127]
    v_mfma_f32_32x32x16_bf16 v[80:95], v[64:67], v[148:151], v[80:95]
    s_waitcnt lgkmcnt(7)
    v_cndmask_b32 v40, v40, v36, s[72:73]
    v_cndmask_b32 v41, v41, v36, s[72:73]
    v_cndmask_b32 v42, v42, v36, s[72:73]
    v_cndmask_b32 v43, v43, v36, s[72:73]
    v_mfma_f32_32x32x16_bf16 v[96:111], v[44:47], v[152:155], v[96:111]
    s_add_u32 m0, s98, 50176
    s_add_u32 s57, s99, 731136
    buffer_load_dwordx4 v5, s[8:11], s57 offen lds
    v_mfma_f32_32x32x16_bf16 v[112:127], v[48:51], v[152:155], v[112:127]
    v_mfma_f32_32x32x16_bf16 v[80:95], v[40:43], v[152:155], v[80:95]
    s_waitcnt vmcnt(12) lgkmcnt(0)
    s_barrier
    ds_read_b128 v[160:163], v12 offset:0
    ds_read_b64_tr_b16 v[64:65], v240 offset:0
    ds_read_b64_tr_b16 v[66:67], v240 offset:256
    ds_read_b64_tr_b16 v[68:69], v241 offset:0
    ds_read_b64_tr_b16 v[70:71], v241 offset:256
    ds_read_b64_tr_b16 v[72:73], v242 offset:0
    ds_read_b64_tr_b16 v[74:75], v242 offset:256
    ds_read_b128 v[164:167], v13 offset:0
    ds_read_b64_tr_b16 v[40:41], v240 offset:1024
    ds_read_b64_tr_b16 v[42:43], v240 offset:1280
    ds_read_b64_tr_b16 v[44:45], v241 offset:1024
    ds_read_b64_tr_b16 v[46:47], v241 offset:1280
    ds_read_b64_tr_b16 v[48:49], v242 offset:1024
    ds_read_b64_tr_b16 v[50:51], v242 offset:1280
    v_cndmask_b32 v52, v52, v36, s[72:73]
    v_cndmask_b32 v53, v53, v36, s[72:73]
    v_cndmask_b32 v54, v54, v36, s[72:73]
    v_cndmask_b32 v55, v55, v36, s[72:73]
    v_mfma_f32_32x32x16_bf16 v[96:111], v[56:59], v[156:159], v[96:111]
    s_add_u32 m0, s96, 65536
    s_add_u32 s57, s97, 640
    buffer_load_dwordx4 v3, s[4:7], s57 offen lds
    v_mfma_f32_32x32x16_bf16 v[112:127], v[60:63], v[156:159], v[112:127]
    v_mfma_f32_32x32x16_bf16 v[80:95], v[52:55], v[156:159], v[80:95]
    ds_read_b128 v[168:171], v14 offset:0
    ds_read_b64_tr_b16 v[52:53], v240 offset:2048
    ds_read_b64_tr_b16 v[54:55], v240 offset:2304
    ds_read_b64_tr_b16 v[56:57], v241 offset:2048
    ds_read_b64_tr_b16 v[58:59], v241 offset:2304
    ds_read_b64_tr_b16 v[60:61], v242 offset:2048
    ds_read_b64_tr_b16 v[62:63], v242 offset:2304
    s_waitcnt lgkmcnt(14)
    v_cndmask_b32 v64, v64, v36, s[72:73]
    v_cndmask_b32 v65, v65, v36, s[72:73]
    v_cndmask_b32 v66, v66, v36, s[72:73]
    v_cndmask_b32 v67, v67, v36, s[72:73]
    v_mfma_f32_32x32x16_bf16 v[96:111], v[68:71], v[160:163], v[96:111]
    s_add_u32 m0, s96, 66560
    s_add_u32 s57, s97, 7808
    buffer_load_dwordx4 v4, s[4:7], s57 offen lds
    v_mfma_f32_32x32x16_bf16 v[112:127], v[72:75], v[160:163], v[112:127]
    v_mfma_f32_32x32x16_bf16 v[80:95], v[64:67], v[160:163], v[80:95]
    ds_read_b128 v[172:175], v15 offset:0
    ds_read_b64_tr_b16 v[64:65], v240 offset:3072
    ds_read_b64_tr_b16 v[66:67], v240 offset:3328
    ds_read_b64_tr_b16 v[68:69], v241 offset:3072
    ds_read_b64_tr_b16 v[70:71], v241 offset:3328
    ds_read_b64_tr_b16 v[72:73], v242 offset:3072
    ds_read_b64_tr_b16 v[74:75], v242 offset:3328
    s_waitcnt lgkmcnt(14)
    v_cndmask_b32 v40, v40, v36, s[72:73]
    v_cndmask_b32 v41, v41, v36, s[72:73]
    v_cndmask_b32 v42, v42, v36, s[72:73]
    v_cndmask_b32 v43, v43, v36, s[72:73]
    v_mfma_f32_32x32x16_bf16 v[96:111], v[44:47], v[164:167], v[96:111]
    s_add_u32 m0, s98, 81920
    s_add_u32 s57, s99, 860160
    buffer_load_dwordx4 v5, s[8:11], s57 offen lds
    v_mfma_f32_32x32x16_bf16 v[112:127], v[48:51], v[164:167], v[112:127]
    v_mfma_f32_32x32x16_bf16 v[80:95], v[40:43], v[164:167], v[80:95]
    s_waitcnt lgkmcnt(7)
    v_cndmask_b32 v52, v52, v36, s[72:73]
    v_cndmask_b32 v53, v53, v36, s[72:73]
    v_cndmask_b32 v54, v54, v36, s[72:73]
    v_cndmask_b32 v55, v55, v36, s[72:73]
    v_mfma_f32_32x32x16_bf16 v[96:111], v[56:59], v[168:171], v[96:111]
    s_add_u32 m0, s98, 82944
    s_add_u32 s57, s99, 903168
    buffer_load_dwordx4 v5, s[8:11], s57 offen lds
    v_mfma_f32_32x32x16_bf16 v[112:127], v[60:63], v[168:171], v[112:127]
    v_mfma_f32_32x32x16_bf16 v[80:95], v[52:55], v[168:171], v[80:95]
    s_waitcnt vmcnt(8) lgkmcnt(0)
    s_barrier
    ds_read_b128 v[176:179], v12 offset:32768
    ds_read_b64_tr_b16 v[40:41], v240 offset:32768
    ds_read_b64_tr_b16 v[42:43], v240 offset:33024
    ds_read_b64_tr_b16 v[44:45], v241 offset:32768
    ds_read_b64_tr_b16 v[46:47], v241 offset:33024
    ds_read_b64_tr_b16 v[48:49], v242 offset:32768
    ds_read_b64_tr_b16 v[50:51], v242 offset:33024
    ds_read_b128 v[180:183], v13 offset:32768
    ds_read_b64_tr_b16 v[52:53], v240 offset:33792
    ds_read_b64_tr_b16 v[54:55], v240 offset:34048
    ds_read_b64_tr_b16 v[56:57], v241 offset:33792
    ds_read_b64_tr_b16 v[58:59], v241 offset:34048
    ds_read_b64_tr_b16 v[60:61], v242 offset:33792
    ds_read_b64_tr_b16 v[62:63], v242 offset:34048
    v_cndmask_b32 v64, v64, v36, s[72:73]
    v_cndmask_b32 v65, v65, v36, s[72:73]
    v_cndmask_b32 v66, v66, v36, s[72:73]
    v_cndmask_b32 v67, v67, v36, s[72:73]
    v_mfma_f32_32x32x16_bf16 v[96:111], v[68:71], v[172:175], v[96:111]
    s_add_u32 m0, s96, 98304
    s_add_u32 s57, s97, 768
    buffer_load_dwordx4 v3, s[4:7], s57 offen lds
    v_mfma_f32_32x32x16_bf16 v[112:127], v[72:75], v[172:175], v[112:127]
    v_mfma_f32_32x32x16_bf16 v[80:95], v[64:67], v[172:175], v[80:95]
    ds_read_b128 v[184:187], v14 offset:32768
    ds_read_b64_tr_b16 v[64:65], v240 offset:34816
    ds_read_b64_tr_b16 v[66:67], v240 offset:35072
    ds_read_b64_tr_b16 v[68:69], v241 offset:34816
    ds_read_b64_tr_b16 v[70:71], v241 offset:35072
    ds_read_b64_tr_b16 v[72:73], v242 offset:34816
    ds_read_b64_tr_b16 v[74:75], v242 offset:35072
    s_waitcnt lgkmcnt(14)
    v_cndmask_b32 v40, v40, v36, s[72:73]
    v_cndmask_b32 v41, v41, v36, s[72:73]
    v_cndmask_b32 v42, v42, v36, s[72:73]
    v_cndmask_b32 v43, v43, v36, s[72:73]
    v_mfma_f32_32x32x16_bf16 v[96:111], v[44:47], v[176:179], v[96:111]
    s_add_u32 m0, s96, 99328
    s_add_u32 s57, s97, 7936
    buffer_load_dwordx4 v4, s[4:7], s57 offen lds
    s_add_u32 m0, s98, 114688
    s_add_u32 s57, s99, 1032192
    buffer_load_dwordx4 v5, s[8:11], s57 offen lds
    v_mfma_f32_32x32x16_bf16 v[112:127], v[48:51], v[176:179], v[112:127]
    v_mfma_f32_32x32x16_bf16 v[80:95], v[40:43], v[176:179], v[80:95]
    ds_read_b128 v[188:191], v15 offset:32768
    ds_read_b64_tr_b16 v[40:41], v240 offset:35840
    ds_read_b64_tr_b16 v[42:43], v240 offset:36096
    ds_read_b64_tr_b16 v[44:45], v241 offset:35840
    ds_read_b64_tr_b16 v[46:47], v241 offset:36096
    ds_read_b64_tr_b16 v[48:49], v242 offset:35840
    ds_read_b64_tr_b16 v[50:51], v242 offset:36096
    s_waitcnt lgkmcnt(14)
    v_cndmask_b32 v52, v52, v36, s[72:73]
    v_cndmask_b32 v53, v53, v36, s[72:73]
    v_cndmask_b32 v54, v54, v36, s[72:73]
    v_cndmask_b32 v55, v55, v36, s[72:73]
    v_mfma_f32_32x32x16_bf16 v[96:111], v[56:59], v[180:183], v[96:111]
    s_add_u32 m0, s98, 115712
    s_add_u32 s57, s99, 1075200
    buffer_load_dwordx4 v5, s[8:11], s57 offen lds
    v_mfma_f32_32x32x16_bf16 v[112:127], v[60:63], v[180:183], v[112:127]
    v_mfma_f32_32x32x16_bf16 v[80:95], v[52:55], v[180:183], v[80:95]
    s_waitcnt lgkmcnt(7)
    v_cndmask_b32 v64, v64, v36, s[72:73]
    v_cndmask_b32 v65, v65, v36, s[72:73]
    v_cndmask_b32 v66, v66, v36, s[72:73]
    v_cndmask_b32 v67, v67, v36, s[72:73]
    v_mfma_f32_32x32x16_bf16 v[96:111], v[68:71], v[184:187], v[96:111]
    v_mfma_f32_32x32x16_bf16 v[112:127], v[72:75], v[184:187], v[112:127]
    v_mfma_f32_32x32x16_bf16 v[80:95], v[64:67], v[184:187], v[80:95]
    s_waitcnt vmcnt(8) lgkmcnt(0)
    s_barrier
    ds_read_b128 v[192:195], v8 offset:0
    ds_read_b64_tr_b16 v[52:53], v16 offset:0
    ds_read_b64_tr_b16 v[54:55], v16 offset:256
    ds_read_b64_tr_b16 v[56:57], v17 offset:0
    ds_read_b64_tr_b16 v[58:59], v17 offset:256
    ds_read_b64_tr_b16 v[60:61], v18 offset:0
    ds_read_b64_tr_b16 v[62:63], v18 offset:256
    ds_read_b128 v[196:199], v9 offset:0
    ds_read_b64_tr_b16 v[64:65], v16 offset:1024
    ds_read_b64_tr_b16 v[66:67], v16 offset:1280
    ds_read_b64_tr_b16 v[68:69], v17 offset:1024
    ds_read_b64_tr_b16 v[70:71], v17 offset:1280
    ds_read_b64_tr_b16 v[72:73], v18 offset:1024
    ds_read_b64_tr_b16 v[74:75], v18 offset:1280
    v_cndmask_b32 v40, v40, v36, s[72:73]
    v_cndmask_b32 v41, v41, v36, s[72:73]
    v_cndmask_b32 v42, v42, v36, s[72:73]
    v_cndmask_b32 v43, v43, v36, s[72:73]
    v_mfma_f32_32x32x16_bf16 v[96:111], v[44:47], v[188:191], v[96:111]
    v_mov_b32 v244, 155648
    v_lshl_add_u32 v244, v1, 2, v244
    v_mov_b32 v245, 0
    ds_write_b32 v244, v245
    v_mfma_f32_32x32x16_bf16 v[112:127], v[48:51], v[188:191], v[112:127]
    v_mfma_f32_32x32x16_bf16 v[80:95], v[40:43], v[188:191], v[80:95]
    ds_read_b128 v[200:203], v10 offset:0
    ds_read_b64_tr_b16 v[40:41], v16 offset:2048
    ds_read_b64_tr_b16 v[42:43], v16 offset:2304
    ds_read_b64_tr_b16 v[44:45], v17 offset:2048
    ds_read_b64_tr_b16 v[46:47], v17 offset:2304
    ds_read_b64_tr_b16 v[48:49], v18 offset:2048
    ds_read_b64_tr_b16 v[50:51], v18 offset:2304
    s_waitcnt lgkmcnt(14)
    v_cndmask_b32 v52, v52, v36, s[72:73]
    v_cndmask_b32 v53, v53, v36, s[72:73]
    v_cndmask_b32 v54, v54, v36, s[72:73]
    v_cndmask_b32 v55, v55, v36, s[72:73]
    v_mfma_f32_32x32x16_bf16 v[96:111], v[56:59], v[192:195], v[96:111]
    v_mfma_f32_32x32x16_bf16 v[112:127], v[60:63], v[192:195], v[112:127]
    v_mfma_f32_32x32x16_bf16 v[80:95], v[52:55], v[192:195], v[80:95]
    ds_read_b128 v[204:207], v11 offset:0
    ds_read_b64_tr_b16 v[52:53], v16 offset:3072
    ds_read_b64_tr_b16 v[54:55], v16 offset:3328
    ds_read_b64_tr_b16 v[56:57], v17 offset:3072
    ds_read_b64_tr_b16 v[58:59], v17 offset:3328
    ds_read_b64_tr_b16 v[60:61], v18 offset:3072
    ds_read_b64_tr_b16 v[62:63], v18 offset:3328
    s_waitcnt lgkmcnt(14)
    v_cndmask_b32 v64, v64, v36, s[72:73]
    v_cndmask_b32 v65, v65, v36, s[72:73]
    v_cndmask_b32 v66, v66, v36, s[72:73]
    v_cndmask_b32 v67, v67, v36, s[72:73]
    v_mfma_f32_32x32x16_bf16 v[96:111], v[68:71], v[196:199], v[96:111]
    v_mfma_f32_32x32x16_bf16 v[112:127], v[72:75], v[196:199], v[112:127]
    v_mfma_f32_32x32x16_bf16 v[80:95], v[64:67], v[196:199], v[80:95]
    s_waitcnt lgkmcnt(7)
    v_cndmask_b32 v40, v40, v36, s[72:73]
    v_cndmask_b32 v41, v41, v36, s[72:73]
    v_cndmask_b32 v42, v42, v36, s[72:73]
    v_cndmask_b32 v43, v43, v36, s[72:73]
    v_mfma_f32_32x32x16_bf16 v[96:111], v[44:47], v[200:203], v[96:111]
    v_mfma_f32_32x32x16_bf16 v[112:127], v[48:51], v[200:203], v[112:127]
    v_mfma_f32_32x32x16_bf16 v[80:95], v[40:43], v[200:203], v[80:95]
    s_waitcnt vmcnt(4) lgkmcnt(0)
    s_barrier
    ds_read_b128 v[208:211], v8 offset:32768
    ds_read_b64_tr_b16 v[64:65], v16 offset:32768
    ds_read_b64_tr_b16 v[66:67], v16 offset:33024
    ds_read_b64_tr_b16 v[68:69], v17 offset:32768
    ds_read_b64_tr_b16 v[70:71], v17 offset:33024
    ds_read_b64_tr_b16 v[72:73], v18 offset:32768
    ds_read_b64_tr_b16 v[74:75], v18 offset:33024
    ds_read_b128 v[212:215], v9 offset:32768
    ds_read_b64_tr_b16 v[40:41], v16 offset:33792
    ds_read_b64_tr_b16 v[42:43], v16 offset:34048
    ds_read_b64_tr_b16 v[44:45], v17 offset:33792
    ds_read_b64_tr_b16 v[46:47], v17 offset:34048
    ds_read_b64_tr_b16 v[48:49], v18 offset:33792
    ds_read_b64_tr_b16 v[50:51], v18 offset:34048
    v_cndmask_b32 v52, v52, v36, s[72:73]
    v_cndmask_b32 v53, v53, v36, s[72:73]
    v_cndmask_b32 v54, v54, v36, s[72:73]
    v_cndmask_b32 v55, v55, v36, s[72:73]
    v_mfma_f32_32x32x16_bf16 v[96:111], v[56:59], v[204:207], v[96:111]
    v_mfma_f32_32x32x16_bf16 v[112:127], v[60:63], v[204:207], v[112:127]
    v_mfma_f32_32x32x16_bf16 v[80:95], v[52:55], v[204:207], v[80:95]
    ds_read_b128 v[216:219], v10 offset:32768
    ds_read_b64_tr_b16 v[52:53], v16 offset:34816
    ds_read_b64_tr_b16 v[54:55], v16 offset:35072
    ds_read_b64_tr_b16 v[56:57], v17 offset:34816
    ds_read_b64_tr_b16 v[58:59], v17 offset:35072
    ds_read_b64_tr_b16 v[60:61], v18 offset:34816
    ds_read_b64_tr_b16 v[62:63], v18 offset:35072
    s_waitcnt lgkmcnt(14)
    v_cndmask_b32 v64, v64, v36, s[72:73]
    v_cndmask_b32 v65, v65, v36, s[72:73]
    v_cndmask_b32 v66, v66, v36, s[72:73]
    v_cndmask_b32 v67, v67, v36, s[72:73]
    v_mfma_f32_32x32x16_bf16 v[96:111], v[68:71], v[208:211], v[96:111]
    v_mfma_f32_32x32x16_bf16 v[112:127], v[72:75], v[208:211], v[112:127]
    v_mfma_f32_32x32x16_bf16 v[80:95], v[64:67], v[208:211], v[80:95]
    ds_read_b128 v[220:223], v11 offset:32768
    ds_read_b64_tr_b16 v[64:65], v16 offset:35840
    ds_read_b64_tr_b16 v[66:67], v16 offset:36096
    ds_read_b64_tr_b16 v[68:69], v17 offset:35840
    ds_read_b64_tr_b16 v[70:71], v17 offset:36096
    ds_read_b64_tr_b16 v[72:73], v18 offset:35840
    ds_read_b64_tr_b16 v[74:75], v18 offset:36096
    s_waitcnt lgkmcnt(14)
    v_cndmask_b32 v40, v40, v36, s[72:73]
    v_cndmask_b32 v41, v41, v36, s[72:73]
    v_cndmask_b32 v42, v42, v36, s[72:73]
    v_cndmask_b32 v43, v43, v36, s[72:73]
    v_mfma_f32_32x32x16_bf16 v[96:111], v[44:47], v[212:215], v[96:111]
    v_mfma_f32_32x32x16_bf16 v[112:127], v[48:51], v[212:215], v[112:127]
    v_mfma_f32_32x32x16_bf16 v[80:95], v[40:43], v[212:215], v[80:95]
    s_waitcnt lgkmcnt(7)
    v_cndmask_b32 v52, v52, v36, s[72:73]
    v_cndmask_b32 v53, v53, v36, s[72:73]
    v_cndmask_b32 v54, v54, v36, s[72:73]
    v_cndmask_b32 v55, v55, v36, s[72:73]
    v_mfma_f32_32x32x16_bf16 v[96:111], v[56:59], v[216:219], v[96:111]
    v_mfma_f32_32x32x16_bf16 v[112:127], v[60:63], v[216:219], v[112:127]
    v_mfma_f32_32x32x16_bf16 v[80:95], v[52:55], v[216:219], v[80:95]
    s_waitcnt vmcnt(0) lgkmcnt(0)
    s_barrier
    ds_read_b128 v[224:227], v12 offset:0
    ds_read_b64_tr_b16 v[40:41], v240 offset:0
    ds_read_b64_tr_b16 v[42:43], v240 offset:256
    ds_read_b64_tr_b16 v[44:45], v241 offset:0
    ds_read_b64_tr_b16 v[46:47], v241 offset:256
    ds_read_b64_tr_b16 v[48:49], v242 offset:0
    ds_read_b64_tr_b16 v[50:51], v242 offset:256
    ds_read_b128 v[228:231], v13 offset:0
    ds_read_b64_tr_b16 v[52:53], v240 offset:1024
    ds_read_b64_tr_b16 v[54:55], v240 offset:1280
    ds_read_b64_tr_b16 v[56:57], v241 offset:1024
    ds_read_b64_tr_b16 v[58:59], v241 offset:1280
    ds_read_b64_tr_b16 v[60:61], v242 offset:1024
    ds_read_b64_tr_b16 v[62:63], v242 offset:1280
    v_cndmask_b32 v64, v64, v36, s[72:73]
    v_cndmask_b32 v65, v65, v36, s[72:73]
    v_cndmask_b32 v66, v66, v36, s[72:73]
    v_cndmask_b32 v67, v67, v36, s[72:73]
    v_mfma_f32_32x32x16_bf16 v[96:111], v[68:71], v[220:223], v[96:111]
    v_mfma_f32_32x32x16_bf16 v[112:127], v[72:75], v[220:223], v[112:127]
    v_mfma_f32_32x32x16_bf16 v[80:95], v[64:67], v[220:223], v[80:95]
    ds_read_b128 v[232:235], v14 offset:0
    ds_read_b64_tr_b16 v[64:65], v240 offset:2048
    ds_read_b64_tr_b16 v[66:67], v240 offset:2304
    ds_read_b64_tr_b16 v[68:69], v241 offset:2048
    ds_read_b64_tr_b16 v[70:71], v241 offset:2304
    ds_read_b64_tr_b16 v[72:73], v242 offset:2048
    ds_read_b64_tr_b16 v[74:75], v242 offset:2304
    s_waitcnt lgkmcnt(14)
    v_cndmask_b32 v40, v40, v36, s[72:73]
    v_cndmask_b32 v41, v41, v36, s[72:73]
    v_cndmask_b32 v42, v42, v36, s[72:73]
    v_cndmask_b32 v43, v43, v36, s[72:73]
    v_mfma_f32_32x32x16_bf16 v[96:111], v[44:47], v[224:227], v[96:111]
    v_mfma_f32_32x32x16_bf16 v[112:127], v[48:51], v[224:227], v[112:127]
    v_mfma_f32_32x32x16_bf16 v[80:95], v[40:43], v[224:227], v[80:95]
    ds_read_b128 v[236:239], v15 offset:0
    ds_read_b64_tr_b16 v[40:41], v240 offset:3072
    ds_read_b64_tr_b16 v[42:43], v240 offset:3328
    ds_read_b64_tr_b16 v[44:45], v241 offset:3072
    ds_read_b64_tr_b16 v[46:47], v241 offset:3328
    ds_read_b64_tr_b16 v[48:49], v242 offset:3072
    ds_read_b64_tr_b16 v[50:51], v242 offset:3328
    s_waitcnt lgkmcnt(14)
    v_cndmask_b32 v52, v52, v36, s[72:73]
    v_cndmask_b32 v53, v53, v36, s[72:73]
    v_cndmask_b32 v54, v54, v36, s[72:73]
    v_cndmask_b32 v55, v55, v36, s[72:73]
    v_mfma_f32_32x32x16_bf16 v[96:111], v[56:59], v[228:231], v[96:111]
    v_mfma_f32_32x32x16_bf16 v[112:127], v[60:63], v[228:231], v[112:127]
    v_mfma_f32_32x32x16_bf16 v[80:95], v[52:55], v[228:231], v[80:95]
    s_waitcnt lgkmcnt(7)
    v_cndmask_b32 v64, v64, v36, s[72:73]
    v_cndmask_b32 v65, v65, v36, s[72:73]
    v_cndmask_b32 v66, v66, v36, s[72:73]
    v_cndmask_b32 v67, v67, v36, s[72:73]
    v_mfma_f32_32x32x16_bf16 v[96:111], v[68:71], v[232:235], v[96:111]
    v_mfma_f32_32x32x16_bf16 v[112:127], v[72:75], v[232:235], v[112:127]
    v_mfma_f32_32x32x16_bf16 v[80:95], v[64:67], v[232:235], v[80:95]
    s_waitcnt lgkmcnt(0)
    v_cndmask_b32 v40, v40, v36, s[72:73]
    v_cndmask_b32 v41, v41, v36, s[72:73]
    v_cndmask_b32 v42, v42, v36, s[72:73]
    v_cndmask_b32 v43, v43, v36, s[72:73]
    v_mfma_f32_32x32x16_bf16 v[96:111], v[44:47], v[236:239], v[96:111]
    v_mfma_f32_32x32x16_bf16 v[112:127], v[48:51], v[236:239], v[112:127]
    v_mfma_f32_32x32x16_bf16 v[80:95], v[40:43], v[236:239], v[80:95]
    v_and_b32 v25, 31, v1
    s_lshl_b32 s57, s22, 7
    s_add_u32 s57, s57, 155904
    v_lshl_add_u32 v25, v25, 2, s57
    s_nop 7
    v_mov_b32 v54, v92
    v_mov_b32 v55, v92
    s_nop 1
    v_permlane32_swap_b32 v54, v55
    ds_write_b32 v25, v55 offset:512
    v_mov_b32 v34, v55
    s_waitcnt lgkmcnt(0)
    s_barrier
    ds_read_b32 v35, v25
    s_waitcnt lgkmcnt(0)
    v_mul_f32 v34, 0x3b124925, v34
    v_mul_f32 v35, 0x3b124925, v35
    v_fma_f32 v35, -v34, v34, v35
    v_max_f32 v35, 0, v35
    v_add_f32 v35, 0x3727c5ac, v35
    v_rsq_f32 v32, v35
    s_nop 0
    v_mul_f32 v33, v35, v32
    v_cvt_pk_bf16_f32 v54, v34, v34
    v_and_b32 v54, 0xffff0000, v54
    v_sub_f32 v55, v34, v54
    v_cvt_pk_bf16_f32 v28, -v54, -v54
    v_cvt_pk_bf16_f32 v29, -v55, -v55
    v_cvt_pk_bf16_f32 v54, v33, v33
    v_and_b32 v54, 0xffff0000, v54
    v_sub_f32 v55, v33, v54
    v_cvt_pk_bf16_f32 v30, v54, v55
    v_cmp_gt_u32 vcc, 32, v1
    s_nop 1
    v_cndmask_b32 v28, 0, v28, vcc
    v_cndmask_b32 v29, 0, v29, vcc
    v_cndmask_b32 v30, 0, v30, vcc
    v_mov_b32 v31, 0
    s_setprio 3
    v_lshrrev_b32 v25, 5, v1
    v_lshlrev_b32 v25, 4, v25
    v_add_u32 v27, 157696, v25
    v_mul_f32 v57, 0x3e8b97f6, v32
    v_cmp_le_u32 s[72:73], 32, v1
    s_lshl_b32 s70, s22, 11
    s_add_u32 s70, s70, 131072
    v_and_b32 v24, 31, v1
    v_lshlrev_b32 v24, 6, v24
    v_lshrrev_b32 v25, 5, v1
    v_lshl_add_u32 v24, v25, 3, v24
    v_add_u32 v24, s70, v24
    v_lshrrev_b32 v25, 5, v1
    v_lshlrev_b32 v25, 8, v25
    v_bfe_u32 v26, v1, 2, 2
    v_lshl_add_u32 v25, v26, 6, v25
    v_bfe_u32 v26, v1, 4, 1
    v_lshl_add_u32 v25, v26, 5, v25
    v_and_b32 v26, 3, v1
    v_lshl_add_u32 v25, v26, 3, v25
    v_add_u32 v25, s70, v25
    s_mov_b32 s88, s60
    s_mov_b32 s89, s61
    s_mul_i32 s64, s21, 3
    s_add_u32 s64, s64, s37
    s_lshr_b32 s65, s64, 4
    s_and_b32 s64, s64, 15
    s_lshl_b32 s66, s64, 6
    s_add_u32 s66, s66, s71
    s_cmp_eq_u32 s65, 0
    s_cselect_b64 s[80:81], -1, 0
    v_cndmask_b32 v56, v32, v57, s[80:81]
    s_lshl_b32 s57, s37, 7
    v_add_u32 v26, s57, v27
    ds_read_b128 v[8:11], v26 offset:0
    ds_read_b128 v[12:15], v26 offset:32
    ds_read_b128 v[16:19], v26 offset:64
    ds_read_b128 v[20:23], v26 offset:96
    v_mul_f32 v35, -v34, v56
    v_mul_f32 v80, v56, v80
    v_mul_f32 v81, v56, v81
    v_mul_f32 v82, v56, v82
    v_mul_f32 v83, v56, v83
    v_mul_f32 v84, v56, v84
    v_mul_f32 v85, v56, v85
    v_mul_f32 v86, v56, v86
    v_mul_f32 v87, v56, v87
    v_mul_f32 v88, v56, v88
    v_mul_f32 v89, v56, v89
    v_mul_f32 v90, v56, v90
    v_mul_f32 v91, v56, v91
    v_mul_f32 v92, v56, v92
    v_mul_f32 v93, v56, v93
    v_mul_f32 v94, v56, v94
    v_mul_f32 v95, v56, v95
    s_waitcnt lgkmcnt(0)
    v_fmac_f32 v80, v35, v8
    v_fmac_f32 v81, v35, v9
    v_fmac_f32 v82, v35, v10
    v_fmac_f32 v83, v35, v11
    v_fmac_f32 v84, v35, v12
    v_fmac_f32 v85, v35, v13
    v_fmac_f32 v86, v35, v14
    v_fmac_f32 v87, v35, v15
    v_fmac_f32 v88, v35, v16
    v_fmac_f32 v89, v35, v17
    v_fmac_f32 v90, v35, v18
    v_fmac_f32 v91, v35, v19
    v_fmac_f32 v92, v35, v20
    v_fmac_f32 v93, v35, v21
    v_fmac_f32 v94, v35, v22
    v_fmac_f32 v95, v35, v23
    v_cvt_pk_bf16_f32 v40, v80, v81
    v_cvt_pk_bf16_f32 v41, v82, v83
    v_cvt_pk_bf16_f32 v42, v84, v85
    v_cvt_pk_bf16_f32 v43, v86, v87
    v_cvt_pk_bf16_f32 v44, v88, v89
    v_cvt_pk_bf16_f32 v45, v90, v91
    v_cvt_pk_bf16_f32 v46, v92, v93
    v_cvt_pk_bf16_f32 v47, v94, v95
    s_mov_b32 s67, 0
    s_mov_b32 s68, 0
    s_cmp_eq_u32 s65, 1
    s_cselect_b32 s67, 0x3f803f80, s67
    s_cselect_b32 s68, 0x00003f80, s68
    s_cmp_eq_u32 s65, 2
    s_cselect_b32 s67, 0x00003f80, s67
    v_mov_b32 v58, s67
    v_mov_b32 v59, s68
    v_cndmask_b32 v46, v46, v58, s[72:73]
    v_cndmask_b32 v47, v47, v59, s[72:73]
    s_cbranch_scc1 EV_1
    s_lshl_b32 s67, s66, 11
    s_lshl_b32 s68, s66, 12
    s_add_u32 s68, s68, 2097152
    s_cmp_eq_u32 s65, 0
    s_cselect_b32 s67, s67, s68
    buffer_store_dwordx4 v[40:43], v6, s[12:15], s67 offen sc1
    buffer_store_dwordx4 v[44:47], v6, s[12:15], s67 offen offset:1024 sc1
    s_branch EE_2
EV_1:
    ds_write_b64 v24, v[40:41] offset:0
    ds_write_b64 v24, v[42:43] offset:16
    ds_write_b64 v24, v[44:45] offset:32
    ds_write_b64 v24, v[46:47] offset:48
    s_waitcnt lgkmcnt(0)
    ds_read_b64_tr_b16 v[60:61], v25 offset:0
    ds_read_b64_tr_b16 v[62:63], v25 offset:512
    ds_read_b64_tr_b16 v[64:65], v25 offset:1024
    ds_read_b64_tr_b16 v[66:67], v25 offset:1536
    s_lshl_b32 s68, s66, 12
    s_add_u32 s68, s68, 2099200
    s_waitcnt lgkmcnt(0)
    buffer_store_dwordx4 v[60:63], v6, s[12:15], s68 offen sc1
    buffer_store_dwordx4 v[64:67], v6, s[12:15], s68 offen offset:1024 sc1
    s_nop 1
EE_2:
    s_mul_i32 s64, s21, 3
    s_add_u32 s64, s64, s38
    s_lshr_b32 s65, s64, 4
    s_and_b32 s64, s64, 15
    s_lshl_b32 s66, s64, 6
    s_add_u32 s66, s66, s71
    s_cmp_eq_u32 s65, 0
    s_cselect_b64 s[80:81], -1, 0
    v_cndmask_b32 v56, v32, v57, s[80:81]
    s_lshl_b32 s57, s38, 7
    v_add_u32 v26, s57, v27
    ds_read_b128 v[8:11], v26 offset:0
    ds_read_b128 v[12:15], v26 offset:32
    ds_read_b128 v[16:19], v26 offset:64
    ds_read_b128 v[20:23], v26 offset:96
    v_mul_f32 v35, -v34, v56
    v_mul_f32 v96, v56, v96
    v_mul_f32 v97, v56, v97
    v_mul_f32 v98, v56, v98
    v_mul_f32 v99, v56, v99
    v_mul_f32 v100, v56, v100
    v_mul_f32 v101, v56, v101
    v_mul_f32 v102, v56, v102
    v_mul_f32 v103, v56, v103
    v_mul_f32 v104, v56, v104
    v_mul_f32 v105, v56, v105
    v_mul_f32 v106, v56, v106
    v_mul_f32 v107, v56, v107
    v_mul_f32 v108, v56, v108
    v_mul_f32 v109, v56, v109
    v_mul_f32 v110, v56, v110
    v_mul_f32 v111, v56, v111
    s_waitcnt lgkmcnt(0)
    v_fmac_f32 v96, v35, v8
    v_fmac_f32 v97, v35, v9
    v_fmac_f32 v98, v35, v10
    v_fmac_f32 v99, v35, v11
    v_fmac_f32 v100, v35, v12
    v_fmac_f32 v101, v35, v13
    v_fmac_f32 v102, v35, v14
    v_fmac_f32 v103, v35, v15
    v_fmac_f32 v104, v35, v16
    v_fmac_f32 v105, v35, v17
    v_fmac_f32 v106, v35, v18
    v_fmac_f32 v107, v35, v19
    v_fmac_f32 v108, v35, v20
    v_fmac_f32 v109, v35, v21
    v_fmac_f32 v110, v35, v22
    v_fmac_f32 v111, v35, v23
    v_cvt_pk_bf16_f32 v48, v96, v97
    v_cvt_pk_bf16_f32 v49, v98, v99
    v_cvt_pk_bf16_f32 v50, v100, v101
    v_cvt_pk_bf16_f32 v51, v102, v103
    v_cvt_pk_bf16_f32 v52, v104, v105
    v_cvt_pk_bf16_f32 v53, v106, v107
    v_cvt_pk_bf16_f32 v54, v108, v109
    v_cvt_pk_bf16_f32 v55, v110, v111
    s_mov_b32 s67, 0
    s_mov_b32 s68, 0
    s_cmp_eq_u32 s65, 1
    s_cselect_b32 s67, 0x3f803f80, s67
    s_cselect_b32 s68, 0x00003f80, s68
    s_cmp_eq_u32 s65, 2
    s_cselect_b32 s67, 0x00003f80, s67
    v_mov_b32 v58, s67
    v_mov_b32 v59, s68
    v_cndmask_b32 v54, v54, v58, s[72:73]
    v_cndmask_b32 v55, v55, v59, s[72:73]
    s_cbranch_scc1 EV_3
    s_lshl_b32 s67, s66, 11
    s_lshl_b32 s68, s66, 12
    s_add_u32 s68, s68, 2097152
    s_cmp_eq_u32 s65, 0
    s_cselect_b32 s67, s67, s68
    buffer_store_dwordx4 v[48:51], v6, s[12:15], s67 offen sc1
    buffer_store_dwordx4 v[52:55], v6, s[12:15], s67 offen offset:1024 sc1
    s_branch EE_4
EV_3:
    ds_write_b64 v24, v[48:49] offset:0
    ds_write_b64 v24, v[50:51] offset:16
    ds_write_b64 v24, v[52:53] offset:32
    ds_write_b64 v24, v[54:55] offset:48
    s_waitcnt lgkmcnt(0)
    ds_read_b64_tr_b16 v[60:61], v25 offset:0
    ds_read_b64_tr_b16 v[62:63], v25 offset:512
    ds_read_b64_tr_b16 v[64:65], v25 offset:1024
    ds_read_b64_tr_b16 v[66:67], v25 offset:1536
    s_lshl_b32 s68, s66, 12
    s_add_u32 s68, s68, 2099200
    s_waitcnt lgkmcnt(0)
    buffer_store_dwordx4 v[60:63], v6, s[12:15], s68 offen sc1
    buffer_store_dwordx4 v[64:67], v6, s[12:15], s68 offen offset:1024 sc1
    s_nop 1
EE_4:
    s_mul_i32 s64, s21, 3
    s_add_u32 s64, s64, s39
    s_lshr_b32 s65, s64, 4
    s_and_b32 s64, s64, 15
    s_lshl_b32 s66, s64, 6
    s_add_u32 s66, s66, s71
    s_cmp_eq_u32 s65, 0
    s_cselect_b64 s[80:81], -1, 0
    v_cndmask_b32 v56, v32, v57, s[80:81]
    s_lshl_b32 s57, s39, 7
    v_add_u32 v26, s57, v27
    ds_read_b128 v[8:11], v26 offset:0
    ds_read_b128 v[12:15], v26 offset:32
    ds_read_b128 v[16:19], v26 offset:64
    ds_read_b128 v[20:23], v26 offset:96
    v_mul_f32 v35, -v34, v56
    v_mul_f32 v112, v56, v112
    v_mul_f32 v113, v56, v113
    v_mul_f32 v114, v56, v114
    v_mul_f32 v115, v56, v115
    v_mul_f32 v116, v56, v116
    v_mul_f32 v117, v56, v117
    v_mul_f32 v118, v56, v118
    v_mul_f32 v119, v56, v119
    v_mul_f32 v120, v56, v120
    v_mul_f32 v121, v56, v121
    v_mul_f32 v122, v56, v122
    v_mul_f32 v123, v56, v123
    v_mul_f32 v124, v56, v124
    v_mul_f32 v125, v56, v125
    v_mul_f32 v126, v56, v126
    v_mul_f32 v127, v56, v127
    s_waitcnt lgkmcnt(0)
    v_fmac_f32 v112, v35, v8
    v_fmac_f32 v113, v35, v9
    v_fmac_f32 v114, v35, v10
    v_fmac_f32 v115, v35, v11
    v_fmac_f32 v116, v35, v12
    v_fmac_f32 v117, v35, v13
    v_fmac_f32 v118, v35, v14
    v_fmac_f32 v119, v35, v15
    v_fmac_f32 v120, v35, v16
    v_fmac_f32 v121, v35, v17
    v_fmac_f32 v122, v35, v18
    v_fmac_f32 v123, v35, v19
    v_fmac_f32 v124, v35, v20
    v_fmac_f32 v125, v35, v21
    v_fmac_f32 v126, v35, v22
    v_fmac_f32 v127, v35, v23
    v_cvt_pk_bf16_f32 v68, v112, v113
    v_cvt_pk_bf16_f32 v69, v114, v115
    v_cvt_pk_bf16_f32 v70, v116, v117
    v_cvt_pk_bf16_f32 v71, v118, v119
    v_cvt_pk_bf16_f32 v72, v120, v121
    v_cvt_pk_bf16_f32 v73, v122, v123
    v_cvt_pk_bf16_f32 v74, v124, v125
    v_cvt_pk_bf16_f32 v75, v126, v127
    s_mov_b32 s67, 0
    s_mov_b32 s68, 0
    s_cmp_eq_u32 s65, 1
    s_cselect_b32 s67, 0x3f803f80, s67
    s_cselect_b32 s68, 0x00003f80, s68
    s_cmp_eq_u32 s65, 2
    s_cselect_b32 s67, 0x00003f80, s67
    v_mov_b32 v58, s67
    v_mov_b32 v59, s68
    v_cndmask_b32 v74, v74, v58, s[72:73]
    v_cndmask_b32 v75, v75, v59, s[72:73]
    s_cbranch_scc1 EV_5
    s_lshl_b32 s67, s66, 11
    s_lshl_b32 s68, s66, 12
    s_add_u32 s68, s68, 2097152
    s_cmp_eq_u32 s65, 0
    s_cselect_b32 s67, s67, s68
    buffer_store_dwordx4 v[68:71], v6, s[12:15], s67 offen sc1
    buffer_store_dwordx4 v[72:75], v6, s[12:15], s67 offen offset:1024 sc1
    s_branch EE_6
EV_5:
    ds_write_b64 v24, v[68:69] offset:0
    ds_write_b64 v24, v[70:71] offset:16
    ds_write_b64 v24, v[72:73] offset:32
    ds_write_b64 v24, v[74:75] offset:48
    s_waitcnt lgkmcnt(0)
    ds_read_b64_tr_b16 v[60:61], v25 offset:0
    ds_read_b64_tr_b16 v[62:63], v25 offset:512
    ds_read_b64_tr_b16 v[64:65], v25 offset:1024
    ds_read_b64_tr_b16 v[66:67], v25 offset:1536
    s_lshl_b32 s68, s66, 12
    s_add_u32 s68, s68, 2099200
    s_waitcnt lgkmcnt(0)
    buffer_store_dwordx4 v[60:63], v6, s[12:15], s68 offen sc1
    buffer_store_dwordx4 v[64:67], v6, s[12:15], s68 offen offset:1024 sc1
    s_nop 1
EE_6:
    s_setprio 0
    v_lshrrev_b32 v20, 5, v1
    v_lshlrev_b32 v20, 9, v20
    v_bfe_u32 v25, v1, 2, 2
    v_lshl_add_u32 v20, v25, 6, v20
    v_bfe_u32 v25, v1, 4, 1
    v_lshl_add_u32 v20, v25, 5, v20
    v_and_b32 v25, 3, v1
    v_lshl_add_u32 v20, v25, 3, v20
    v_add_u32 v21, 0x10000, v20
    v_add_u32 v22, 0x10000, v21
    v_mul_f32 v243, 0xc0135761, v32
    v_mul_f32 v244, v32, v32
    v_mul_f32 v244, v244, v32
    v_mul_f32 v244, 0xbdd2d3e8, v244
    v_mov_b32 v245, v33
    s_mul_i32 s64, s71, 112*1024
    s_add_u32 s64, s64, 6291456
    s_lshr_b32 s69, s22, 1
    v_mov_b32 v24, 155672
LW_7:
    ds_read_b32 v25, v24
    s_waitcnt lgkmcnt(0)
    v_readfirstlane_b32 s57, v25
    s_nop 0
    s_cmp_ge_u32 s57, 4
    s_cbranch_scc0 LW_7
    ds_read_b64_tr_b16 v[40:41], v21 offset:0
    ds_read_b64_tr_b16 v[42:43], v21 offset:256
    ds_read_b64_tr_b16 v[44:45], v21 offset:1024
    ds_read_b64_tr_b16 v[46:47], v21 offset:1280
    ds_read_b64_tr_b16 v[48:49], v21 offset:2048
    ds_read_b64_tr_b16 v[50:51], v21 offset:2304
    ds_read_b64_tr_b16 v[52:53], v21 offset:3072
    ds_read_b64_tr_b16 v[54:55], v21 offset:3328
    ds_read_b64_tr_b16 v[56:57], v21 offset:4096
    ds_read_b64_tr_b16 v[58:59], v21 offset:4352
    ds_read_b64_tr_b16 v[60:61], v21 offset:5120
    ds_read_b64_tr_b16 v[62:63], v21 offset:5376
    s_waitcnt lgkmcnt(10)
    v_mfma_f32_32x32x16_bf16 v[64:79], v[40:43], v[128:131], 0
    ds_read_b64_tr_b16 v[40:41], v21 offset:6144
    ds_read_b64_tr_b16 v[42:43], v21 offset:6400
    s_waitcnt lgkmcnt(10)
    v_mfma_f32_32x32x16_bf16 v[64:79], v[44:47], v[132:135], v[64:79]
    ds_read_b64_tr_b16 v[44:45], v21 offset:7168
    ds_read_b64_tr_b16 v[46:47], v21 offset:7424
    s_waitcnt lgkmcnt(10)
    v_mfma_f32_32x32x16_bf16 v[64:79], v[48:51], v[136:139], v[64:79]
    ds_read_b64_tr_b16 v[48:49], v21 offset:8192
    ds_read_b64_tr_b16 v[50:51], v21 offset:8448
    s_waitcnt lgkmcnt(10)
    v_mfma_f32_32x32x16_bf16 v[64:79], v[52:55], v[140:143], v[64:79]
    ds_read_b64_tr_b16 v[52:53], v21 offset:9216
    ds_read_b64_tr_b16 v[54:55], v21 offset:9472
    s_waitcnt lgkmcnt(10)
    v_mfma_f32_32x32x16_bf16 v[64:79], v[56:59], v[144:147], v[64:79]
    ds_read_b64_tr_b16 v[56:57], v21 offset:10240
    ds_read_b64_tr_b16 v[58:59], v21 offset:10496
    s_waitcnt lgkmcnt(10)
    v_mfma_f32_32x32x16_bf16 v[64:79], v[60:63], v[148:151], v[64:79]
    ds_read_b64_tr_b16 v[60:61], v21 offset:11264
    ds_read_b64_tr_b16 v[62:63], v21 offset:11520
    s_waitcnt lgkmcnt(10)
    v_mfma_f32_32x32x16_bf16 v[64:79], v[40:43], v[152:155], v[64:79]
    ds_read_b64_tr_b16 v[40:41], v21 offset:12288
    ds_read_b64_tr_b16 v[42:43], v21 offset:12544
    s_waitcnt lgkmcnt(10)
    v_mfma_f32_32x32x16_bf16 v[64:79], v[44:47], v[156:159], v[64:79]
    ds_read_b64_tr_b16 v[44:45], v21 offset:13312
    ds_read_b64_tr_b16 v[46:47], v21 offset:13568
    s_waitcnt lgkmcnt(10)
    v_mfma_f32_32x32x16_bf16 v[64:79], v[48:51], v[160:163], v[64:79]
    ds_read_b64_tr_b16 v[48:49], v21 offset:14336
    ds_read_b64_tr_b16 v[50:51], v21 offset:14592
    s_waitcnt lgkmcnt(10)
    v_mfma_f32_32x32x16_bf16 v[64:79], v[52:55], v[164:167], v[64:79]
    ds_read_b64_tr_b16 v[52:53], v21 offset:15360
    ds_read_b64_tr_b16 v[54:55], v21 offset:15616
    s_waitcnt lgkmcnt(10)
    v_mfma_f32_32x32x16_bf16 v[64:79], v[56:59], v[168:171], v[64:79]
    ds_read_b64_tr_b16 v[56:57], v21 offset:16384
    ds_read_b64_tr_b16 v[58:59], v21 offset:16640
    s_waitcnt lgkmcnt(10)
    v_mfma_f32_32x32x16_bf16 v[64:79], v[60:63], v[172:175], v[64:79]
    ds_read_b64_tr_b16 v[60:61], v21 offset:17408
    ds_read_b64_tr_b16 v[62:63], v21 offset:17664
    s_waitcnt lgkmcnt(10)
    v_mfma_f32_32x32x16_bf16 v[64:79], v[40:43], v[176:179], v[64:79]
    ds_read_b64_tr_b16 v[40:41], v21 offset:18432
    ds_read_b64_tr_b16 v[42:43], v21 offset:18688
    s_waitcnt lgkmcnt(10)
    v_mfma_f32_32x32x16_bf16 v[64:79], v[44:47], v[180:183], v[64:79]
    ds_read_b64_tr_b16 v[44:45], v21 offset:19456
    ds_read_b64_tr_b16 v[46:47], v21 offset:19712
    s_waitcnt lgkmcnt(10)
    v_mfma_f32_32x32x16_bf16 v[64:79], v[48:51], v[184:187], v[64:79]
    ds_read_b64_tr_b16 v[48:49], v21 offset:20480
    ds_read_b64_tr_b16 v[50:51], v21 offset:20736
    s_waitcnt lgkmcnt(10)
    v_mfma_f32_32x32x16_bf16 v[64:79], v[52:55], v[188:191], v[64:79]
    ds_read_b64_tr_b16 v[52:53], v21 offset:21504
    ds_read_b64_tr_b16 v[54:55], v21 offset:21760
    s_waitcnt lgkmcnt(10)
    v_mfma_f32_32x32x16_bf16 v[64:79], v[56:59], v[192:195], v[64:79]
    ds_read_b64_tr_b16 v[56:57], v21 offset:22528
    ds_read_b64_tr_b16 v[58:59], v21 offset:22784
    s_waitcnt lgkmcnt(10)
    v_mfma_f32_32x32x16_bf16 v[64:79], v[60:63], v[196:199], v[64:79]
    ds_read_b64_tr_b16 v[60:61], v21 offset:23552
    ds_read_b64_tr_b16 v[62:63], v21 offset:23808
    s_waitcnt lgkmcnt(10)
    v_mfma_f32_32x32x16_bf16 v[64:79], v[40:43], v[200:203], v[64:79]
    ds_read_b64_tr_b16 v[40:41], v21 offset:24576
    ds_read_b64_tr_b16 v[42:43], v21 offset:24832
    s_waitcnt lgkmcnt(10)
    v_mfma_f32_32x32x16_bf16 v[64:79], v[44:47], v[204:207], v[64:79]
    ds_read_b64_tr_b16 v[44:45], v21 offset:25600
    ds_read_b64_tr_b16 v[46:47], v21 offset:25856
    s_waitcnt lgkmcnt(10)
    v_mfma_f32_32x32x16_bf16 v[64:79], v[48:51], v[208:211], v[64:79]
    ds_read_b64_tr_b16 v[48:49], v21 offset:26624
    ds_read_b64_tr_b16 v[50:51], v21 offset:26880
    s_waitcnt lgkmcnt(10)
    v_mfma_f32_32x32x16_bf16 v[64:79], v[52:55], v[212:215], v[64:79]
    ds_read_b64_tr_b16 v[52:53], v21 offset:27648
    ds_read_b64_tr_b16 v[54:55], v21 offset:27904
    s_waitcnt lgkmcnt(10)
    v_mfma_f32_32x32x16_bf16 v[64:79], v[56:59], v[216:219], v[64:79]
    s_waitcnt lgkmcnt(8)
    v_mfma_f32_32x32x16_bf16 v[64:79], v[60:63], v[220:223], v[64:79]
    s_waitcnt lgkmcnt(6)
    v_mfma_f32_32x32x16_bf16 v[64:79], v[40:43], v[224:227], v[64:79]
    s_waitcnt lgkmcnt(4)
    v_mfma_f32_32x32x16_bf16 v[64:79], v[44:47], v[228:231], v[64:79]
    s_waitcnt lgkmcnt(2)
    v_mfma_f32_32x32x16_bf16 v[64:79], v[48:51], v[232:235], v[64:79]
    s_waitcnt lgkmcnt(0)
    v_mfma_f32_32x32x16_bf16 v[64:79], v[52:55], v[236:239], v[64:79]
    s_waitcnt vmcnt(0)
    s_lshl_b32 s91, s21, 8
    s_lshl_b32 s57, s20, 2
    s_add_u32 s91, s91, s57
    s_add_u32 s91, s91, 17309696
    v_mov_b32 v56, 155652
    v_mov_b32 v57, 1
    s_mov_b64 s[58:59], exec
    s_mov_b64 exec, 1
    ds_add_rtn_u32 v58, v56, v57
    s_waitcnt lgkmcnt(0)
    v_readfirstlane_b32 s57, v58
    s_mov_b64 exec, s[58:59]
    s_cmp_eq_u32 s57, 3
    s_cbranch_scc0 SIG_8
    v_mov_b32 v56, s56
    v_mov_b32 v57, 0
    s_mov_b64 s[58:59], exec
    s_mov_b64 exec, 1
    buffer_store_dword v56, v57, s[12:15], s91 offen sc0 sc1
    s_mov_b64 exec, s[58:59]
SIG_8:
    v_add_u32 v25, 144384, v6
    ds_read_b128 v[36:39], v25
    s_waitcnt lgkmcnt(0)
    v_mfma_f32_32x32x16_bf16 v[64:79], v[36:39], v[28:31], v[64:79]
    s_and_b32 s57, s21, 1
    s_cmp_eq_u32 s57, s69
    s_nop 8
    s_cbranch_scc0 F3SK_9
    v_mov_b32 v24, 155676
LW_11:
    ds_read_b32 v25, v24
    s_waitcnt lgkmcnt(0)
    v_readfirstlane_b32 s57, v25
    s_nop 0
    s_cmp_ge_u32 s57, 4
    s_cbranch_scc0 LW_11
    ds_read_b64_tr_b16 v[40:41], v21 offset:32768
    ds_read_b64_tr_b16 v[42:43], v21 offset:33024
    ds_read_b64_tr_b16 v[44:45], v21 offset:33792
    ds_read_b64_tr_b16 v[46:47], v21 offset:34048
    ds_read_b64_tr_b16 v[48:49], v21 offset:34816
    ds_read_b64_tr_b16 v[50:51], v21 offset:35072
    ds_read_b64_tr_b16 v[52:53], v21 offset:35840
    ds_read_b64_tr_b16 v[54:55], v21 offset:36096
    ds_read_b64_tr_b16 v[56:57], v21 offset:36864
    ds_read_b64_tr_b16 v[58:59], v21 offset:37120
    ds_read_b64_tr_b16 v[60:61], v21 offset:37888
    ds_read_b64_tr_b16 v[62:63], v21 offset:38144
    s_waitcnt lgkmcnt(10)
    v_mfma_f32_32x32x16_bf16 v[80:95], v[40:43], v[128:131], 0
    v_mul_f32 v96, v64, v64
    v_mul_f32 v97, v65, v65
    v_mul_f32 v98, v66, v66
    v_mul_f32 v99, v67, v67
    v_mul_f32 v100, v68, v68
    ds_read_b64_tr_b16 v[40:41], v21 offset:38912
    ds_read_b64_tr_b16 v[42:43], v21 offset:39168
    s_waitcnt lgkmcnt(10)
    v_mfma_f32_32x32x16_bf16 v[80:95], v[44:47], v[132:135], v[80:95]
    v_mul_f32 v101, v69, v69
    v_mul_f32 v102, v70, v70
    v_mul_f32 v103, v71, v71
    v_fma_f32 v96, v96, v244, v243
    v_fma_f32 v97, v97, v244, v243
    ds_read_b64_tr_b16 v[44:45], v21 offset:39936
    ds_read_b64_tr_b16 v[46:47], v21 offset:40192
    s_waitcnt lgkmcnt(10)
    v_mfma_f32_32x32x16_bf16 v[80:95], v[48:51], v[136:139], v[80:95]
    v_fma_f32 v98, v98, v244, v243
    v_fma_f32 v99, v99, v244, v243
    v_fma_f32 v100, v100, v244, v243
    v_fma_f32 v101, v101, v244, v243
    v_fma_f32 v102, v102, v244, v243
    ds_read_b64_tr_b16 v[48:49], v21 offset:40960
    ds_read_b64_tr_b16 v[50:51], v21 offset:41216
    s_waitcnt lgkmcnt(10)
    v_mfma_f32_32x32x16_bf16 v[80:95], v[52:55], v[140:143], v[80:95]
    v_fma_f32 v103, v103, v244, v243
    v_mul_f32 v96, v96, v64
    v_mul_f32 v97, v97, v65
    v_mul_f32 v98, v98, v66
    v_mul_f32 v99, v99, v67
    ds_read_b64_tr_b16 v[52:53], v21 offset:41984
    ds_read_b64_tr_b16 v[54:55], v21 offset:42240
    s_waitcnt lgkmcnt(10)
    v_mfma_f32_32x32x16_bf16 v[80:95], v[56:59], v[144:147], v[80:95]
    v_mul_f32 v100, v100, v68
    v_mul_f32 v101, v101, v69
    v_mul_f32 v102, v102, v70
    v_mul_f32 v103, v103, v71
    v_exp_f32 v96, v96
    ds_read_b64_tr_b16 v[56:57], v21 offset:43008
    ds_read_b64_tr_b16 v[58:59], v21 offset:43264
    s_waitcnt lgkmcnt(10)
    v_mfma_f32_32x32x16_bf16 v[80:95], v[60:63], v[148:151], v[80:95]
    v_exp_f32 v97, v97
    v_exp_f32 v98, v98
    v_exp_f32 v99, v99
    v_exp_f32 v100, v100
    v_exp_f32 v101, v101
    ds_read_b64_tr_b16 v[60:61], v21 offset:44032
    ds_read_b64_tr_b16 v[62:63], v21 offset:44288
    s_waitcnt lgkmcnt(10)
    v_mfma_f32_32x32x16_bf16 v[80:95], v[40:43], v[152:155], v[80:95]
    v_exp_f32 v102, v102
    v_exp_f32 v103, v103
    v_fma_f32 v96, v96, v245, v245
    v_fma_f32 v97, v97, v245, v245
    v_fma_f32 v98, v98, v245, v245
    ds_read_b64_tr_b16 v[40:41], v21 offset:45056
    ds_read_b64_tr_b16 v[42:43], v21 offset:45312
    s_waitcnt lgkmcnt(10)
    v_mfma_f32_32x32x16_bf16 v[80:95], v[44:47], v[156:159], v[80:95]
    v_fma_f32 v99, v99, v245, v245
    v_fma_f32 v100, v100, v245, v245
    v_fma_f32 v101, v101, v245, v245
    v_fma_f32 v102, v102, v245, v245
    v_fma_f32 v103, v103, v245, v245
    ds_read_b64_tr_b16 v[44:45], v21 offset:46080
    ds_read_b64_tr_b16 v[46:47], v21 offset:46336
    s_waitcnt lgkmcnt(10)
    v_mfma_f32_32x32x16_bf16 v[80:95], v[48:51], v[160:163], v[80:95]
    v_rcp_f32 v96, v96
    v_rcp_f32 v97, v97
    v_rcp_f32 v98, v98
    v_rcp_f32 v99, v99
    v_rcp_f32 v100, v100
    ds_read_b64_tr_b16 v[48:49], v21 offset:47104
    ds_read_b64_tr_b16 v[50:51], v21 offset:47360
    s_waitcnt lgkmcnt(10)
    v_mfma_f32_32x32x16_bf16 v[80:95], v[52:55], v[164:167], v[80:95]
    v_rcp_f32 v101, v101
    v_rcp_f32 v102, v102
    v_rcp_f32 v103, v103
    v_mul_f32 v96, v96, v64
    v_mul_f32 v97, v97, v65
    ds_read_b64_tr_b16 v[52:53], v21 offset:48128
    ds_read_b64_tr_b16 v[54:55], v21 offset:48384
    s_waitcnt lgkmcnt(10)
    v_mfma_f32_32x32x16_bf16 v[80:95], v[56:59], v[168:171], v[80:95]
    v_mul_f32 v98, v98, v66
    v_mul_f32 v99, v99, v67
    v_mul_f32 v100, v100, v68
    v_mul_f32 v101, v101, v69
    v_mul_f32 v102, v102, v70
    ds_read_b64_tr_b16 v[56:57], v21 offset:49152
    ds_read_b64_tr_b16 v[58:59], v21 offset:49408
    s_waitcnt lgkmcnt(10)
    v_mfma_f32_32x32x16_bf16 v[80:95], v[60:63], v[172:175], v[80:95]
    v_mul_f32 v103, v103, v71
    v_mul_f32 v104, v72, v72
    v_mul_f32 v105, v73, v73
    v_mul_f32 v106, v74, v74
    v_mul_f32 v107, v75, v75
    ds_read_b64_tr_b16 v[60:61], v21 offset:50176
    ds_read_b64_tr_b16 v[62:63], v21 offset:50432
    s_waitcnt lgkmcnt(10)
    v_mfma_f32_32x32x16_bf16 v[80:95], v[40:43], v[176:179], v[80:95]
    v_mul_f32 v108, v76, v76
    v_mul_f32 v109, v77, v77
    v_mul_f32 v110, v78, v78
    v_mul_f32 v111, v79, v79
    v_fma_f32 v104, v104, v244, v243
    ds_read_b64_tr_b16 v[40:41], v21 offset:51200
    ds_read_b64_tr_b16 v[42:43], v21 offset:51456
    s_waitcnt lgkmcnt(10)
    v_mfma_f32_32x32x16_bf16 v[80:95], v[44:47], v[180:183], v[80:95]
    v_fma_f32 v105, v105, v244, v243
    v_fma_f32 v106, v106, v244, v243
    v_fma_f32 v107, v107, v244, v243
    v_fma_f32 v108, v108, v244, v243
    v_fma_f32 v109, v109, v244, v243
    ds_read_b64_tr_b16 v[44:45], v21 offset:52224
    ds_read_b64_tr_b16 v[46:47], v21 offset:52480
    s_waitcnt lgkmcnt(10)
    v_mfma_f32_32x32x16_bf16 v[80:95], v[48:51], v[184:187], v[80:95]
    v_fma_f32 v110, v110, v244, v243
    v_fma_f32 v111, v111, v244, v243
    v_mul_f32 v104, v104, v72
    v_mul_f32 v105, v105, v73
    v_mul_f32 v106, v106, v74
    ds_read_b64_tr_b16 v[48:49], v21 offset:53248
    ds_read_b64_tr_b16 v[50:51], v21 offset:53504
    s_waitcnt lgkmcnt(10)
    v_mfma_f32_32x32x16_bf16 v[80:95], v[52:55], v[188:191], v[80:95]
    v_mul_f32 v107, v107, v75
    v_mul_f32 v108, v108, v76
    v_mul_f32 v109, v109, v77
    v_mul_f32 v110, v110, v78
    v_mul_f32 v111, v111, v79
    ds_read_b64_tr_b16 v[52:53], v21 offset:54272
    ds_read_b64_tr_b16 v[54:55], v21 offset:54528
    s_waitcnt lgkmcnt(10)
    v_mfma_f32_32x32x16_bf16 v[80:95], v[56:59], v[192:195], v[80:95]
    v_exp_f32 v104, v104
    v_exp_f32 v105, v105
    v_exp_f32 v106, v106
    v_exp_f32 v107, v107
    v_exp_f32 v108, v108
    ds_read_b64_tr_b16 v[56:57], v21 offset:55296
    ds_read_b64_tr_b16 v[58:59], v21 offset:55552
    s_waitcnt lgkmcnt(10)
    v_mfma_f32_32x32x16_bf16 v[80:95], v[60:63], v[196:199], v[80:95]
    v_exp_f32 v109, v109
    v_exp_f32 v110, v110
    v_exp_f32 v111, v111
    v_fma_f32 v104, v104, v245, v245
    v_fma_f32 v105, v105, v245, v245
    ds_read_b64_tr_b16 v[60:61], v21 offset:56320
    ds_read_b64_tr_b16 v[62:63], v21 offset:56576
    s_waitcnt lgkmcnt(10)
    v_mfma_f32_32x32x16_bf16 v[80:95], v[40:43], v[200:203], v[80:95]
    v_fma_f32 v106, v106, v245, v245
    v_fma_f32 v107, v107, v245, v245
    v_fma_f32 v108, v108, v245, v245
    v_fma_f32 v109, v109, v245, v245
    v_fma_f32 v110, v110, v245, v245
    ds_read_b64_tr_b16 v[40:41], v21 offset:57344
    ds_read_b64_tr_b16 v[42:43], v21 offset:57600
    s_waitcnt lgkmcnt(10)
    v_mfma_f32_32x32x16_bf16 v[80:95], v[44:47], v[204:207], v[80:95]
    v_fma_f32 v111, v111, v245, v245
    v_rcp_f32 v104, v104
    v_rcp_f32 v105, v105
    v_rcp_f32 v106, v106
    v_rcp_f32 v107, v107
    ds_read_b64_tr_b16 v[44:45], v21 offset:58368
    ds_read_b64_tr_b16 v[46:47], v21 offset:58624
    s_waitcnt lgkmcnt(10)
    v_mfma_f32_32x32x16_bf16 v[80:95], v[48:51], v[208:211], v[80:95]
    v_rcp_f32 v108, v108
    v_rcp_f32 v109, v109
    v_rcp_f32 v110, v110
    v_rcp_f32 v111, v111
    v_mul_f32 v104, v104, v72
    ds_read_b64_tr_b16 v[48:49], v21 offset:59392
    ds_read_b64_tr_b16 v[50:51], v21 offset:59648
    s_waitcnt lgkmcnt(10)
    v_mfma_f32_32x32x16_bf16 v[80:95], v[52:55], v[212:215], v[80:95]
    v_mul_f32 v105, v105, v73
    v_mul_f32 v106, v106, v74
    v_mul_f32 v107, v107, v75
    v_mul_f32 v108, v108, v76
    v_mul_f32 v109, v109, v77
    ds_read_b64_tr_b16 v[52:53], v21 offset:60416
    ds_read_b64_tr_b16 v[54:55], v21 offset:60672
    s_waitcnt lgkmcnt(10)
    v_mfma_f32_32x32x16_bf16 v[80:95], v[56:59], v[216:219], v[80:95]
    v_mul_f32 v110, v110, v78
    v_mul_f32 v111, v111, v79
    v_cvt_pk_bf16_f32 v112, v96, v97
    v_cvt_pk_bf16_f32 v113, v98, v99
    v_cvt_pk_bf16_f32 v114, v100, v101
    s_waitcnt lgkmcnt(8)
    v_mfma_f32_32x32x16_bf16 v[80:95], v[60:63], v[220:223], v[80:95]
    v_cvt_pk_bf16_f32 v115, v102, v103
    v_cvt_pk_bf16_f32 v116, v104, v105
    v_cvt_pk_bf16_f32 v117, v106, v107
    v_cvt_pk_bf16_f32 v118, v108, v109
    v_cvt_pk_bf16_f32 v119, v110, v111
    s_waitcnt lgkmcnt(6)
    v_mfma_f32_32x32x16_bf16 v[80:95], v[40:43], v[224:227], v[80:95]
    s_lshl_b32 s67, s62, 5
    s_add_u32 s67, s67, s64
    buffer_store_dwordx4 v[112:115], v6, s[12:15], s67 offen sc1
    buffer_store_dwordx4 v[116:119], v6, s[12:15], s67 offen offset:1024 sc1
    s_waitcnt lgkmcnt(4)
    v_mfma_f32_32x32x16_bf16 v[80:95], v[44:47], v[228:231], v[80:95]
    s_waitcnt lgkmcnt(2)
    v_mfma_f32_32x32x16_bf16 v[80:95], v[48:51], v[232:235], v[80:95]
    s_waitcnt lgkmcnt(0)
    v_mfma_f32_32x32x16_bf16 v[80:95], v[52:55], v[236:239], v[80:95]
    v_add_u32 v25, 145408, v6
    ds_read_b128 v[36:39], v25
    s_waitcnt lgkmcnt(0)
    v_mfma_f32_32x32x16_bf16 v[80:95], v[36:39], v[28:31], v[80:95]
    s_nop 11
    v_mul_f32 v96, v80, v80
    v_mul_f32 v97, v81, v81
    v_mul_f32 v98, v82, v82
    v_mul_f32 v99, v83, v83
    v_mul_f32 v100, v84, v84
    v_mul_f32 v101, v85, v85
    v_mul_f32 v102, v86, v86
    v_mul_f32 v103, v87, v87
    v_fma_f32 v96, v96, v244, v243
    v_fma_f32 v97, v97, v244, v243
    v_fma_f32 v98, v98, v244, v243
    v_fma_f32 v99, v99, v244, v243
    v_fma_f32 v100, v100, v244, v243
    v_fma_f32 v101, v101, v244, v243
    v_fma_f32 v102, v102, v244, v243
    v_fma_f32 v103, v103, v244, v243
    v_mul_f32 v96, v96, v80
    v_mul_f32 v97, v97, v81
    v_mul_f32 v98, v98, v82
    v_mul_f32 v99, v99, v83
    v_mul_f32 v100, v100, v84
    v_mul_f32 v101, v101, v85
    v_mul_f32 v102, v102, v86
    v_mul_f32 v103, v103, v87
    v_exp_f32 v96, v96
    v_exp_f32 v97, v97
    v_exp_f32 v98, v98
    v_exp_f32 v99, v99
    v_exp_f32 v100, v100
    v_exp_f32 v101, v101
    v_exp_f32 v102, v102
    v_exp_f32 v103, v103
    v_fma_f32 v96, v96, v245, v245
    v_fma_f32 v97, v97, v245, v245
    v_fma_f32 v98, v98, v245, v245
    v_fma_f32 v99, v99, v245, v245
    v_fma_f32 v100, v100, v245, v245
    v_fma_f32 v101, v101, v245, v245
    v_fma_f32 v102, v102, v245, v245
    v_fma_f32 v103, v103, v245, v245
    v_rcp_f32 v96, v96
    v_rcp_f32 v97, v97
    v_rcp_f32 v98, v98
    v_rcp_f32 v99, v99
    v_rcp_f32 v100, v100
    v_rcp_f32 v101, v101
    v_rcp_f32 v102, v102
    v_rcp_f32 v103, v103
    v_mul_f32 v96, v96, v80
    v_mul_f32 v97, v97, v81
    v_mul_f32 v98, v98, v82
    v_mul_f32 v99, v99, v83
    v_mul_f32 v100, v100, v84
    v_mul_f32 v101, v101, v85
    v_mul_f32 v102, v102, v86
    v_mul_f32 v103, v103, v87
    v_mul_f32 v104, v88, v88
    v_mul_f32 v105, v89, v89
    v_mul_f32 v106, v90, v90
    v_mul_f32 v107, v91, v91
    v_mul_f32 v108, v92, v92
    v_mul_f32 v109, v93, v93
    v_mul_f32 v110, v94, v94
    v_mul_f32 v111, v95, v95
    v_fma_f32 v104, v104, v244, v243
    v_fma_f32 v105, v105, v244, v243
    v_fma_f32 v106, v106, v244, v243
    v_fma_f32 v107, v107, v244, v243
    v_fma_f32 v108, v108, v244, v243
    v_fma_f32 v109, v109, v244, v243
    v_fma_f32 v110, v110, v244, v243
    v_fma_f32 v111, v111, v244, v243
    v_mul_f32 v104, v104, v88
    v_mul_f32 v105, v105, v89
    v_mul_f32 v106, v106, v90
    v_mul_f32 v107, v107, v91
    v_mul_f32 v108, v108, v92
    v_mul_f32 v109, v109, v93
    v_mul_f32 v110, v110, v94
    v_mul_f32 v111, v111, v95
    v_exp_f32 v104, v104
    v_exp_f32 v105, v105
    v_exp_f32 v106, v106
    v_exp_f32 v107, v107
    v_exp_f32 v108, v108
    v_exp_f32 v109, v109
    v_exp_f32 v110, v110
    v_exp_f32 v111, v111
    v_fma_f32 v104, v104, v245, v245
    v_fma_f32 v105, v105, v245, v245
    v_fma_f32 v106, v106, v245, v245
    v_fma_f32 v107, v107, v245, v245
    v_fma_f32 v108, v108, v245, v245
    v_fma_f32 v109, v109, v245, v245
    v_fma_f32 v110, v110, v245, v245
    v_fma_f32 v111, v111, v245, v245
    v_rcp_f32 v104, v104
    v_rcp_f32 v105, v105
    v_rcp_f32 v106, v106
    v_rcp_f32 v107, v107
    v_rcp_f32 v108, v108
    v_rcp_f32 v109, v109
    v_rcp_f32 v110, v110
    v_rcp_f32 v111, v111
    v_mul_f32 v104, v104, v88
    v_mul_f32 v105, v105, v89
    v_mul_f32 v106, v106, v90
    v_mul_f32 v107, v107, v91
    v_mul_f32 v108, v108, v92
    v_mul_f32 v109, v109, v93
    v_mul_f32 v110, v110, v94
    v_mul_f32 v111, v111, v95
    v_cvt_pk_bf16_f32 v120, v96, v97
    v_cvt_pk_bf16_f32 v121, v98, v99
    v_cvt_pk_bf16_f32 v122, v100, v101
    v_cvt_pk_bf16_f32 v123, v102, v103
    v_cvt_pk_bf16_f32 v124, v104, v105
    v_cvt_pk_bf16_f32 v125, v106, v107
    v_cvt_pk_bf16_f32 v126, v108, v109
    v_cvt_pk_bf16_f32 v127, v110, v111
    s_lshl_b32 s67, s63, 5
    s_add_u32 s67, s67, s64
    buffer_store_dwordx4 v[120:123], v6, s[12:15], s67 offen sc1
    buffer_store_dwordx4 v[124:127], v6, s[12:15], s67 offen offset:1024 sc1
    s_branch F3D_10
F3SK_9:
    v_mul_f32 v96, v64, v64
    v_mul_f32 v97, v65, v65
    v_mul_f32 v98, v66, v66
    v_mul_f32 v99, v67, v67
    v_mul_f32 v100, v68, v68
    v_mul_f32 v101, v69, v69
    v_mul_f32 v102, v70, v70
    v_mul_f32 v103, v71, v71
    v_fma_f32 v96, v96, v244, v243
    v_fma_f32 v97, v97, v244, v243
    v_fma_f32 v98, v98, v244, v243
    v_fma_f32 v99, v99, v244, v243
    v_fma_f32 v100, v100, v244, v243
    v_fma_f32 v101, v101, v244, v243
    v_fma_f32 v102, v102, v244, v243
    v_fma_f32 v103, v103, v244, v243
    v_mul_f32 v96, v96, v64
    v_mul_f32 v97, v97, v65
    v_mul_f32 v98, v98, v66
    v_mul_f32 v99, v99, v67
    v_mul_f32 v100, v100, v68
    v_mul_f32 v101, v101, v69
    v_mul_f32 v102, v102, v70
    v_mul_f32 v103, v103, v71
    v_exp_f32 v96, v96
    v_exp_f32 v97, v97
    v_exp_f32 v98, v98
    v_exp_f32 v99, v99
    v_exp_f32 v100, v100
    v_exp_f32 v101, v101
    v_exp_f32 v102, v102
    v_exp_f32 v103, v103
    v_fma_f32 v96, v96, v245, v245
    v_fma_f32 v97, v97, v245, v245
    v_fma_f32 v98, v98, v245, v245
    v_fma_f32 v99, v99, v245, v245
    v_fma_f32 v100, v100, v245, v245
    v_fma_f32 v101, v101, v245, v245
    v_fma_f32 v102, v102, v245, v245
    v_fma_f32 v103, v103, v245, v245
    v_rcp_f32 v96, v96
    v_rcp_f32 v97, v97
    v_rcp_f32 v98, v98
    v_rcp_f32 v99, v99
    v_rcp_f32 v100, v100
    v_rcp_f32 v101, v101
    v_rcp_f32 v102, v102
    v_rcp_f32 v103, v103
    v_mul_f32 v96, v96, v64
    v_mul_f32 v97, v97, v65
    v_mul_f32 v98, v98, v66
    v_mul_f32 v99, v99, v67
    v_mul_f32 v100, v100, v68
    v_mul_f32 v101, v101, v69
    v_mul_f32 v102, v102, v70
    v_mul_f32 v103, v103, v71
    v_mul_f32 v104, v72, v72
    v_mul_f32 v105, v73, v73
    v_mul_f32 v106, v74, v74
    v_mul_f32 v107, v75, v75
    v_mul_f32 v108, v76, v76
    v_mul_f32 v109, v77, v77
    v_mul_f32 v110, v78, v78
    v_mul_f32 v111, v79, v79
    v_fma_f32 v104, v104, v244, v243
    v_fma_f32 v105, v105, v244, v243
    v_fma_f32 v106, v106, v244, v243
    v_fma_f32 v107, v107, v244, v243
    v_fma_f32 v108, v108, v244, v243
    v_fma_f32 v109, v109, v244, v243
    v_fma_f32 v110, v110, v244, v243
    v_fma_f32 v111, v111, v244, v243
    v_mul_f32 v104, v104, v72
    v_mul_f32 v105, v105, v73
    v_mul_f32 v106, v106, v74
    v_mul_f32 v107, v107, v75
    v_mul_f32 v108, v108, v76
    v_mul_f32 v109, v109, v77
    v_mul_f32 v110, v110, v78
    v_mul_f32 v111, v111, v79
    v_exp_f32 v104, v104
    v_exp_f32 v105, v105
    v_exp_f32 v106, v106
    v_exp_f32 v107, v107
    v_exp_f32 v108, v108
    v_exp_f32 v109, v109
    v_exp_f32 v110, v110
    v_exp_f32 v111, v111
    v_fma_f32 v104, v104, v245, v245
    v_fma_f32 v105, v105, v245, v245
    v_fma_f32 v106, v106, v245, v245
    v_fma_f32 v107, v107, v245, v245
    v_fma_f32 v108, v108, v245, v245
    v_fma_f32 v109, v109, v245, v245
    v_fma_f32 v110, v110, v245, v245
    v_fma_f32 v111, v111, v245, v245
    v_rcp_f32 v104, v104
    v_rcp_f32 v105, v105
    v_rcp_f32 v106, v106
    v_rcp_f32 v107, v107
    v_rcp_f32 v108, v108
    v_rcp_f32 v109, v109
    v_rcp_f32 v110, v110
    v_rcp_f32 v111, v111
    v_mul_f32 v104, v104, v72
    v_mul_f32 v105, v105, v73
    v_mul_f32 v106, v106, v74
    v_mul_f32 v107, v107, v75
    v_mul_f32 v108, v108, v76
    v_mul_f32 v109, v109, v77
    v_mul_f32 v110, v110, v78
    v_mul_f32 v111, v111, v79
    v_cvt_pk_bf16_f32 v112, v96, v97
    v_cvt_pk_bf16_f32 v113, v98, v99
    v_cvt_pk_bf16_f32 v114, v100, v101
    v_cvt_pk_bf16_f32 v115, v102, v103
    v_cvt_pk_bf16_f32 v116, v104, v105
    v_cvt_pk_bf16_f32 v117, v106, v107
    v_cvt_pk_bf16_f32 v118, v108, v109
    v_cvt_pk_bf16_f32 v119, v110, v111
    s_lshl_b32 s67, s62, 5
    s_add_u32 s67, s67, s64
    buffer_store_dwordx4 v[112:115], v6, s[12:15], s67 offen sc1
    buffer_store_dwordx4 v[116:119], v6, s[12:15], s67 offen offset:1024 sc1
F3D_10:
    s_waitcnt vmcnt(0)
    s_branch PH_C
AB_B:
    s_mul_i32 s70, s22, 56
    s_add_u32 s70, s70, s28
    s_mul_i32 s57, s20, 75264
    s_add_u32 s70, s70, s57
    s_add_u32 s57, s70, 0
    buffer_load_dword v72, v25, s[8:11], s57 offen
    s_add_u32 s57, s70, 2688
    buffer_load_dword v73, v25, s[8:11], s57 offen
    s_add_u32 s57, s70, 5376
    buffer_load_dword v74, v25, s[8:11], s57 offen
    s_add_u32 s57, s70, 8064
    buffer_load_dword v75, v25, s[8:11], s57 offen
    s_add_u32 s57, s70, 10752
    buffer_load_dword v76, v25, s[8:11], s57 offen
    s_add_u32 s57, s70, 13440
    buffer_load_dword v77, v25, s[8:11], s57 offen
    s_add_u32 s57, s70, 16128
    buffer_load_dword v78, v25, s[8:11], s57 offen
    s_mul_i32 s57, s20, 100352
    s_add_u32 s70, s68, s57
    s_add_u32 s57, s70, 0
    buffer_load_dword v64, v26, s[16:19], s57 offen
    s_add_u32 s57, s70, 3584
    buffer_load_dword v65, v26, s[16:19], s57 offen
    s_add_u32 s57, s70, 7168
    buffer_load_dword v66, v26, s[16:19], s57 offen
    s_add_u32 s57, s70, 10752
    buffer_load_dword v67, v26, s[16:19], s57 offen
    s_add_u32 s57, s70, 14336
    buffer_load_dword v68, v26, s[16:19], s57 offen
    s_add_u32 s57, s70, 17920
    buffer_load_dword v69, v26, s[16:19], s57 offen
    s_add_u32 s57, s70, 21504
    buffer_load_dword v70, v26, s[16:19], s57 offen
    s_barrier
    s_cmp_eq_u32 s22, 0
    s_cbranch_scc0 WU_12
    v_min_u32 v9, 8, v1
    v_lshlrev_b32 v9, 21, v9
    buffer_load_dword v247, v9, s[12:15], 0 offen sc1
    s_branch WU_14
WU_12:
    s_cmp_eq_u32 s22, 1
    s_cbranch_scc0 WU_13
    v_mov_b32 v9, 0
    global_load_dword v247, v9, s[48:49]
    global_load_dword v247, v9, s[40:41]
    global_load_dword v247, v9, s[52:53]
    global_load_dword v247, v9, s[50:51]
    s_branch WU_14
WU_13:
    s_getpc_b64 s[80:81]
PCREF:
    s_sub_u32 s80, s80, PCREF - parallel_sum__mha_block__dense_activation_gelu__prompt_kernel
    s_subb_u32 s81, s81, 0
    s_lshr_b32 s57, s2, 3
    s_lshl_b32 s57, s57, 1
    s_and_b32 s58, s22, 1
    s_add_u32 s57, s57, s58
    s_lshl_b32 s57, s57, 3
    v_and_b32 v9, 7, v1
    v_add_u32 v9, s57, v9
    v_lshlrev_b32 v9, 7, v9
    v_min_u32 v9, CODE_END - parallel_sum__mha_block__dense_activation_gelu__prompt_kernel - 4, v9
    global_load_dword v247, v9, s[80:81]
WU_14:
    v_and_b32 v9, 31, v1
    s_lshl_b32 s57, s22, 5
    v_add_u32 v9, s57, v9
    v_bfe_u32 v10, v9, 1, 3
    v_lshrrev_b32 v11, 5, v1
    v_xor_b32 v10, v10, v11
    v_lshlrev_b32 v27, 7, v9
    v_mov_b32 v24, v10
    v_xor_b32 v25, 0, v24
    v_lshl_add_u32 v8, v25, 4, v27
    v_add_u32 v8, 0x8000, v8
    v_add_u32 v12, 0x10000, v8
    v_xor_b32 v25, 2, v24
    v_lshl_add_u32 v9, v25, 4, v27
    v_add_u32 v9, 0x8000, v9
    v_add_u32 v13, 0x10000, v9
    v_xor_b32 v25, 4, v24
    v_lshl_add_u32 v10, v25, 4, v27
    v_add_u32 v10, 0x8000, v10
    v_add_u32 v14, 0x10000, v10
    v_xor_b32 v25, 6, v24
    v_lshl_add_u32 v11, v25, 4, v27
    v_add_u32 v11, 0x8000, v11
    v_add_u32 v15, 0x10000, v11
    v_lshrrev_b32 v20, 5, v1
    v_lshlrev_b32 v20, 9, v20
    v_bfe_u32 v25, v1, 2, 2
    v_lshl_add_u32 v20, v25, 6, v20
    v_bfe_u32 v25, v1, 4, 1
    v_lshl_add_u32 v20, v25, 5, v20
    v_and_b32 v25, 3, v1
    v_lshl_add_u32 v20, v25, 3, v20
    v_add_u32 v21, 0x10000, v20
    v_add_u32 v22, 0x10000, v21
    s_and_b32 s57, s28, 63
    v_bfe_u32 v24, v1, 4, 1
    v_lshlrev_b32 v24, 5, v24
    v_and_b32 v25, 3, v1
    v_lshl_add_u32 v24, v25, 3, v24
    v_add_u32 v24, s57, v24
    v_lshrrev_b32 v25, 5, v1
    v_lshlrev_b32 v25, 9, v25
    v_bfe_u32 v26, v1, 2, 2
    v_lshl_add_u32 v25, v26, 6, v25
    s_mov_b32 s37, 0
    v_add_u32 v26, 0, v24
    v_lshrrev_b32 v27, 6, v26
    v_lshlrev_b32 v27, 12, v27
    v_and_b32 v26, 63, v26
    v_add3_u32 v16, v27, v26, v25
    v_add_u32 v16, 49152, v16
    s_lshl_b32 s57, s22, 10
    v_add_u32 v16, s57, v16
    v_add_u32 v240, 0x10000, v16
    s_mov_b32 s38, 1
    v_add_u32 v26, 56, v24
    v_lshrrev_b32 v27, 6, v26
    v_lshlrev_b32 v27, 12, v27
    v_and_b32 v26, 63, v26
    v_add3_u32 v17, v27, v26, v25
    v_add_u32 v17, 49152, v17
    s_lshl_b32 s57, s22, 10
    v_add_u32 v17, s57, v17
    v_add_u32 v241, 0x10000, v17
    s_mov_b32 s39, 2
    v_add_u32 v26, 112, v24
    v_lshrrev_b32 v27, 6, v26
    v_lshlrev_b32 v27, 12, v27
    v_and_b32 v26, 63, v26
    v_add3_u32 v18, v27, v26, v25
    v_add_u32 v18, 49152, v18
    s_lshl_b32 s57, s22, 10
    v_add_u32 v18, s57, v18
    v_add_u32 v242, 0x10000, v18
    s_lshl_b32 s71, s20, 2
    s_add_u32 s71, s71, s22
    v_and_b32 v25, 31, v1
    v_lshlrev_b32 v24, 3, v25
    v_lshrrev_b32 v27, 5, v1
    v_lshl_add_u32 v24, v27, 11, v24
    s_mul_i32 s72, s21, 7
    s_add_u32 s73, s72, s22
    s_add_u32 s73, s73, 3
    s_min_u32 s57, s22, 2
    s_add_u32 s72, s72, s57
    s_lshl_b32 s72, s72, 12
    s_add_u32 s72, s72, 16842752
    s_lshl_b32 s73, s73, 12
    s_add_u32 s73, s73, 16842752
    s_waitcnt vmcnt(4) lgkmcnt(0)
    s_add_u32 s56, s56, 1
    v_mov_b32 v56, 0
    v_mov_b32 v58, 0
    v_lshlrev_b32 v26, 16, v72
    v_and_b32 v27, 0xffff0000, v72
    v_add_f32 v56, v56, v26
    v_add_f32 v58, v58, v27
    v_lshlrev_b32 v26, 16, v73
    v_and_b32 v27, 0xffff0000, v73
    v_add_f32 v56, v56, v26
    v_add_f32 v58, v58, v27
    v_lshlrev_b32 v26, 16, v74
    v_and_b32 v27, 0xffff0000, v74
    v_add_f32 v56, v56, v26
    v_add_f32 v58, v58, v27
    v_lshlrev_b32 v26, 16, v75
    v_and_b32 v27, 0xffff0000, v75
    v_add_f32 v56, v56, v26
    v_add_f32 v58, v58, v27
    v_lshlrev_b32 v26, 16, v76
    v_and_b32 v27, 0xffff0000, v76
    v_add_f32 v56, v56, v26
    v_add_f32 v58, v58, v27
    v_lshlrev_b32 v26, 16, v77
    v_and_b32 v27, 0xffff0000, v77
    v_add_f32 v56, v56, v26
    v_add_f32 v58, v58, v27
    v_lshlrev_b32 v26, 16, v78
    v_and_b32 v27, 0xffff0000, v78
    v_add_f32 v56, v56, v26
    v_add_f32 v58, v58, v27
    v_mov_b32 v60, v56
    v_mov_b32 v61, v56
    s_nop 1
    v_permlane32_swap_b32 v60, v61
    v_add_f32 v56, v60, v61
    v_mov_b32 v60, v56
    v_mov_b32 v61, v56
    s_nop 1
    v_permlane16_swap_b32 v60, v61
    v_add_f32 v56, v60, v61
    v_mov_b32 v60, v58
    v_mov_b32 v61, v58
    s_nop 1
    v_permlane32_swap_b32 v60, v61
    v_add_f32 v58, v60, v61
    v_mov_b32 v60, v58
    v_mov_b32 v61, v58
    s_nop 1
    v_permlane16_swap_b32 v60, v61
    v_add_f32 v58, v60, v61
    v_mov_b32 v57, s56
    v_mov_b32 v59, s56
    s_mul_i32 s57, s21, 7
    s_add_u32 s57, s57, s22
    s_add_u32 s57, s57, 0
    s_lshl_b32 s57, s57, 4
    s_add_u32 s57, s57, s20
    s_lshl_b32 s57, s57, 8
    s_add_u32 s57, s57, 16842752
    s_cmp_eq_u32 s22, 3
    s_cselect_b32 s57, 0x7fffff00, s57
    v_and_b32 v26, 15, v1
    v_lshlrev_b32 v26, 4, v26
    s_mov_b64 s[58:59], exec
    s_mov_b64 exec, 0xffff
    buffer_store_dwordx4 v[56:59], v26, s[12:15], s57 offen sc1
    s_mov_b64 exec, s[58:59]
    s_nop 1
    v_mov_b32 v56, 0
    v_mov_b32 v58, 0
    v_lshlrev_b32 v26, 16, v64
    v_and_b32 v27, 0xffff0000, v64
    v_add_f32 v56, v56, v26
    v_add_f32 v58, v58, v27
    v_lshlrev_b32 v26, 16, v65
    v_and_b32 v27, 0xffff0000, v65
    v_add_f32 v56, v56, v26
    v_add_f32 v58, v58, v27
    v_lshlrev_b32 v26, 16, v66
    v_and_b32 v27, 0xffff0000, v66
    v_add_f32 v56, v56, v26
    v_add_f32 v58, v58, v27
    v_lshlrev_b32 v26, 16, v67
    v_and_b32 v27, 0xffff0000, v67
    v_add_f32 v56, v56, v26
    v_add_f32 v58, v58, v27
    v_lshlrev_b32 v26, 16, v68
    v_and_b32 v27, 0xffff0000, v68
    v_add_f32 v56, v56, v26
    v_add_f32 v58, v58, v27
    v_lshlrev_b32 v26, 16, v69
    v_and_b32 v27, 0xffff0000, v69
    v_add_f32 v56, v56, v26
    v_add_f32 v58, v58, v27
    v_lshlrev_b32 v26, 16, v70
    v_and_b32 v27, 0xffff0000, v70
    v_add_f32 v56, v56, v26
    v_add_f32 v58, v58, v27
    v_mov_b32 v60, v56
    v_mov_b32 v61, v56
    s_nop 1
    v_permlane32_swap_b32 v60, v61
    v_add_f32 v56, v60, v61
    v_mov_b32 v60, v56
    v_mov_b32 v61, v56
    s_nop 1
    v_permlane16_swap_b32 v60, v61
    v_add_f32 v56, v60, v61
    v_mov_b32 v60, v58
    v_mov_b32 v61, v58
    s_nop 1
    v_permlane32_swap_b32 v60, v61
    v_add_f32 v58, v60, v61
    v_mov_b32 v60, v58
    v_mov_b32 v61, v58
    s_nop 1
    v_permlane16_swap_b32 v60, v61
    v_add_f32 v58, v60, v61
    v_mov_b32 v57, s56
    v_mov_b32 v59, s56
    s_mul_i32 s57, s21, 7
    s_add_u32 s57, s57, s22
    s_add_u32 s57, s57, 3
    s_lshl_b32 s57, s57, 4
    s_add_u32 s57, s57, s20
    s_lshl_b32 s57, s57, 8
    s_add_u32 s57, s57, 16842752
    v_and_b32 v26, 15, v1
    v_lshlrev_b32 v26, 4, v26
    s_mov_b64 s[58:59], exec
    s_mov_b64 exec, 0xffff
    buffer_store_dwordx4 v[56:59], v26, s[12:15], s57 offen sc1
    s_mov_b64 exec, s[58:59]
    s_nop 1
    s_add_u32 m0, s35, 0
    s_add_u32 s67, s66, s60
    buffer_load_dwordx4 v7, s[16:19], s67 offen lds
    s_add_u32 m0, s35, 1024
    s_add_u32 s67, s67, 57344
    buffer_load_dwordx4 v7, s[16:19], s67 offen lds
    s_add_u32 m0, s35, 2048
    s_add_u32 s67, s67, 57344
    buffer_load_dwordx4 v7, s[16:19], s67 offen lds
    s_add_u32 m0, s35, 3072
    s_add_u32 s67, s67, 57344
    buffer_load_dwordx4 v7, s[16:19], s67 offen lds
    s_add_u32 m0, s35, 4096
    s_add_u32 s67, s67, 57344
    buffer_load_dwordx4 v7, s[16:19], s67 offen lds
    s_add_u32 m0, s35, 5120
    s_add_u32 s67, s67, 57344
    buffer_load_dwordx4 v7, s[16:19], s67 offen lds
    s_add_u32 m0, s35, 6144
    s_add_u32 s67, s67, 57344
    buffer_load_dwordx4 v7, s[16:19], s67 offen lds
    s_barrier
    s_setprio 2
    ds_read_b128 v[128:131], v8 offset:0
    ds_read_b128 v[132:135], v9 offset:0
    ds_read_b128 v[136:139], v10 offset:0
    s_waitcnt lgkmcnt(2)
    v_mfma_f32_32x32x16_bf16 v[96:111], v[128:131], v[128:131], 0
    ds_read_b128 v[140:143], v11 offset:0
    s_waitcnt lgkmcnt(2)
    v_mfma_f32_32x32x16_bf16 v[96:111], v[132:135], v[132:135], v[96:111]
    s_waitcnt lgkmcnt(1)
    v_mfma_f32_32x32x16_bf16 v[96:111], v[136:139], v[136:139], v[96:111]
    s_waitcnt lgkmcnt(0)
    s_barrier
    ds_read_b128 v[144:147], v8 offset:32768
    ds_read_b128 v[148:151], v9 offset:32768
    v_mfma_f32_32x32x16_bf16 v[96:111], v[140:143], v[140:143], v[96:111]
    s_add_u32 m0, s96, 32768
    s_add_u32 s57, s97, 512
    buffer_load_dwordx4 v3, s[4:7], s57 offen lds
    ds_read_b128 v[152:155], v10 offset:32768
    s_waitcnt lgkmcnt(2)
    v_mfma_f32_32x32x16_bf16 v[96:111], v[144:147], v[144:147], v[96:111]
    s_add_u32 m0, s96, 33792
    s_add_u32 s57, s97, 7680
    buffer_load_dwordx4 v4, s[4:7], s57 offen lds
    ds_read_b128 v[156:159], v11 offset:32768
    s_waitcnt lgkmcnt(2)
    v_mfma_f32_32x32x16_bf16 v[96:111], v[148:151], v[148:151], v[96:111]
    s_add_u32 m0, s98, 49152
    s_add_u32 s57, s99, 688128
    buffer_load_dwordx4 v5, s[8:11], s57 offen lds
    s_waitcnt lgkmcnt(1)
    v_mfma_f32_32x32x16_bf16 v[96:111], v[152:155], v[152:155], v[96:111]
    s_add_u32 m0, s98, 50176
    s_add_u32 s57, s99, 731136
    buffer_load_dwordx4 v5, s[8:11], s57 offen lds
    s_waitcnt lgkmcnt(0)
    s_barrier
    ds_read_b128 v[160:163], v12 offset:0
    ds_read_b128 v[164:167], v13 offset:0
    v_mfma_f32_32x32x16_bf16 v[96:111], v[156:159], v[156:159], v[96:111]
    s_add_u32 m0, s96, 65536
    s_add_u32 s57, s97, 640
    buffer_load_dwordx4 v3, s[4:7], s57 offen lds
    ds_read_b128 v[168:171], v14 offset:0
    s_waitcnt lgkmcnt(2)
    v_mfma_f32_32x32x16_bf16 v[96:111], v[160:163], v[160:163], v[96:111]
    s_add_u32 m0, s96, 66560
    s_add_u32 s57, s97, 7808
    buffer_load_dwordx4 v4, s[4:7], s57 offen lds
    ds_read_b128 v[172:175], v15 offset:0
    s_waitcnt lgkmcnt(2)
    v_mfma_f32_32x32x16_bf16 v[96:111], v[164:167], v[164:167], v[96:111]
    s_add_u32 m0, s98, 81920
    s_add_u32 s57, s99, 860160
    buffer_load_dwordx4 v5, s[8:11], s57 offen lds
    s_waitcnt lgkmcnt(1)
    v_mfma_f32_32x32x16_bf16 v[96:111], v[168:171], v[168:171], v[96:111]
    s_add_u32 m0, s98, 82944
    s_add_u32 s57, s99, 903168
    buffer_load_dwordx4 v5, s[8:11], s57 offen lds
    s_waitcnt lgkmcnt(0)
    s_barrier
    ds_read_b128 v[176:179], v12 offset:32768
    ds_read_b128 v[180:183], v13 offset:32768
    v_mfma_f32_32x32x16_bf16 v[96:111], v[172:175], v[172:175], v[96:111]
    s_add_u32 m0, s96, 98304
    s_add_u32 s57, s97, 768
    buffer_load_dwordx4 v3, s[4:7], s57 offen lds
    ds_read_b128 v[184:187], v14 offset:32768
    s_waitcnt lgkmcnt(2)
    v_mfma_f32_32x32x16_bf16 v[96:111], v[176:179], v[176:179], v[96:111]
    s_add_u32 m0, s96, 99328
    s_add_u32 s57, s97, 7936
    buffer_load_dwordx4 v4, s[4:7], s57 offen lds
    s_add_u32 m0, s98, 114688
    s_add_u32 s57, s99, 1032192
    buffer_load_dwordx4 v5, s[8:11], s57 offen lds
    s_add_u32 m0, s98, 115712
    s_add_u32 s57, s99, 1075200
    buffer_load_dwordx4 v5, s[8:11], s57 offen lds
    ds_read_b128 v[188:191], v15 offset:32768
    s_waitcnt lgkmcnt(2)
    v_mfma_f32_32x32x16_bf16 v[96:111], v[180:183], v[180:183], v[96:111]
    s_waitcnt lgkmcnt(1)
    v_mfma_f32_32x32x16_bf16 v[96:111], v[184:187], v[184:187], v[96:111]
    s_waitcnt vmcnt(8) lgkmcnt(0)
    s_barrier
    ds_read_b128 v[192:195], v8 offset:0
    ds_read_b128 v[196:199], v9 offset:0
    v_mfma_f32_32x32x16_bf16 v[96:111], v[188:191], v[188:191], v[96:111]
    v_mov_b32 v244, 155648
    v_lshl_add_u32 v244, v1, 2, v244
    v_mov_b32 v245, 0
    ds_write_b32 v244, v245
    s_add_u32 s57, s72, 0
    buffer_load_dwordx2 v[64:65], v24, s[12:15], s57 offen sc1
    s_add_u32 s57, s72, 256
    buffer_load_dwordx2 v[66:67], v24, s[12:15], s57 offen sc1
    s_add_u32 s57, s72, 512
    buffer_load_dwordx2 v[68:69], v24, s[12:15], s57 offen sc1
    ds_read_b128 v[200:203], v10 offset:0
    s_waitcnt lgkmcnt(2)
    v_mfma_f32_32x32x16_bf16 v[96:111], v[192:195], v[192:195], v[96:111]
    s_add_u32 s57, s72, 768
    buffer_load_dwordx2 v[70:71], v24, s[12:15], s57 offen sc1
    s_add_u32 s57, s72, 1024
    buffer_load_dwordx2 v[72:73], v24, s[12:15], s57 offen sc1
    s_add_u32 s57, s72, 1280
    buffer_load_dwordx2 v[74:75], v24, s[12:15], s57 offen sc1
    ds_read_b128 v[204:207], v11 offset:0
    s_waitcnt lgkmcnt(2)
    v_mfma_f32_32x32x16_bf16 v[96:111], v[196:199], v[196:199], v[96:111]
    s_add_u32 s57, s72, 1536
    buffer_load_dwordx2 v[76:77], v24, s[12:15], s57 offen sc1
    s_add_u32 s57, s72, 1792
    buffer_load_dwordx2 v[78:79], v24, s[12:15], s57 offen sc1
    s_add_u32 s57, s73, 0
    buffer_load_dwordx2 v[80:81], v24, s[12:15], s57 offen sc1
    s_waitcnt lgkmcnt(1)
    v_mfma_f32_32x32x16_bf16 v[96:111], v[200:203], v[200:203], v[96:111]
    s_add_u32 s57, s73, 256
    buffer_load_dwordx2 v[82:83], v24, s[12:15], s57 offen sc1
    s_add_u32 s57, s73, 512
    buffer_load_dwordx2 v[84:85], v24, s[12:15], s57 offen sc1
    s_add_u32 s57, s73, 768
    buffer_load_dwordx2 v[86:87], v24, s[12:15], s57 offen sc1
    s_waitcnt vmcnt(16) lgkmcnt(0)
    s_barrier
    ds_read_b128 v[208:211], v8 offset:32768
    ds_read_b128 v[212:215], v9 offset:32768
    v_mfma_f32_32x32x16_bf16 v[96:111], v[204:207], v[204:207], v[96:111]
    s_add_u32 s57, s73, 1024
    buffer_load_dwordx2 v[88:89], v24, s[12:15], s57 offen sc1
    s_add_u32 s57, s73, 1280
    buffer_load_dwordx2 v[90:91], v24, s[12:15], s57 offen sc1
    s_add_u32 s57, s73, 1536
    buffer_load_dwordx2 v[92:93], v24, s[12:15], s57 offen sc1
    ds_read_b128 v[216:219], v10 offset:32768
    s_waitcnt lgkmcnt(2)
    v_mfma_f32_32x32x16_bf16 v[96:111], v[208:211], v[208:211], v[96:111]
    s_add_u32 s57, s73, 1792
    buffer_load_dwordx2 v[94:95], v24, s[12:15], s57 offen sc1
    v_and_b32 v25, 31, v1
    v_lshlrev_b32 v25, 1, v25
    buffer_load_ushort v112, v25, s[76:79], s68 offen
    s_add_u32 m0, s35, 32768
    s_add_u32 s67, s66, s61
    buffer_load_dwordx4 v7, s[16:19], s67 offen lds
    ds_read_b128 v[220:223], v11 offset:32768
    s_waitcnt lgkmcnt(2)
    v_mfma_f32_32x32x16_bf16 v[96:111], v[212:215], v[212:215], v[96:111]
    s_add_u32 m0, s35, 33792
    s_add_u32 s67, s67, 57344
    buffer_load_dwordx4 v7, s[16:19], s67 offen lds
    s_add_u32 m0, s35, 34816
    s_add_u32 s67, s67, 57344
    buffer_load_dwordx4 v7, s[16:19], s67 offen lds
    s_add_u32 m0, s35, 35840
    s_add_u32 s67, s67, 57344
    buffer_load_dwordx4 v7, s[16:19], s67 offen lds
    s_waitcnt lgkmcnt(1)
    v_mfma_f32_32x32x16_bf16 v[96:111], v[216:219], v[216:219], v[96:111]
    s_add_u32 m0, s35, 36864
    s_add_u32 s67, s67, 57344
    buffer_load_dwordx4 v7, s[16:19], s67 offen lds
    s_add_u32 m0, s35, 37888
    s_add_u32 s67, s67, 57344
    buffer_load_dwordx4 v7, s[16:19], s67 offen lds
    s_add_u32 m0, s35, 38912
    s_add_u32 s67, s67, 57344
    buffer_load_dwordx4 v7, s[16:19], s67 offen lds
    s_waitcnt vmcnt(24) lgkmcnt(0)
    s_barrier
    ds_read_b128 v[224:227], v12 offset:0
    ds_read_b128 v[228:231], v13 offset:0
    v_mfma_f32_32x32x16_bf16 v[96:111], v[220:223], v[220:223], v[96:111]
    s_add_u32 m0, s35, 65536
    s_add_u32 s67, s66, s62
    buffer_load_dwordx4 v7, s[16:19], s67 offen lds
    s_add_u32 m0, s35, 66560
    s_add_u32 s67, s67, 57344
    buffer_load_dwordx4 v7, s[16:19], s67 offen lds
    s_add_u32 m0, s35, 67584
    s_add_u32 s67, s67, 57344
    buffer_load_dwordx4 v7, s[16:19], s67 offen lds
    ds_read_b128 v[232:235], v14 offset:0
    s_waitcnt lgkmcnt(2)
    v_mfma_f32_32x32x16_bf16 v[96:111], v[224:227], v[224:227], v[96:111]
    s_add_u32 m0, s35, 68608
    s_add_u32 s67, s67, 57344
    buffer_load_dwordx4 v7, s[16:19], s67 offen lds
    s_add_u32 m0, s35, 69632
    s_add_u32 s67, s67, 57344
    buffer_load_dwordx4 v7, s[16:19], s67 offen lds
    s_add_u32 m0, s35, 70656
    s_add_u32 s67, s67, 57344
    buffer_load_dwordx4 v7, s[16:19], s67 offen lds
    ds_read_b128 v[236:239], v15 offset:0
    s_waitcnt lgkmcnt(2)
    v_mfma_f32_32x32x16_bf16 v[96:111], v[228:231], v[228:231], v[96:111]
    s_add_u32 m0, s35, 71680
    s_add_u32 s67, s67, 57344
    buffer_load_dwordx4 v7, s[16:19], s67 offen lds
    s_waitcnt lgkmcnt(1)
    v_mfma_f32_32x32x16_bf16 v[96:111], v[232:235], v[232:235], v[96:111]
    s_waitcnt lgkmcnt(0)
    v_mfma_f32_32x32x16_bf16 v[96:111], v[236:239], v[236:239], v[96:111]
    v_and_b32 v25, 31, v1
    s_lshl_b32 s57, s22, 7
    s_add_u32 s57, s57, 155904
    v_lshl_add_u32 v25, v25, 2, s57
    s_setprio 0
    v_and_b32 v54, 3, v1
    v_cmp_eq_u32 s[82:83], 1, v54
    v_cmp_eq_u32 s[84:85], 2, v54
    v_cmp_eq_u32 s[86:87], 3, v54
    s_nop 2
    v_cndmask_b32 v96, v96, v97, s[82:83]
    v_cndmask_b32 v96, v96, v98, s[84:85]
    v_cndmask_b32 v96, v96, v99, s[86:87]
    v_cndmask_b32 v100, v100, v101, s[82:83]
    v_cndmask_b32 v100, v100, v102, s[84:85]
    v_cndmask_b32 v100, v100, v103, s[86:87]
    v_cndmask_b32 v104, v104, v105, s[82:83]
    v_cndmask_b32 v104, v104, v106, s[84:85]
    v_cndmask_b32 v104, v104, v107, s[86:87]
    v_cndmask_b32 v108, v108, v109, s[82:83]
    v_cndmask_b32 v108, v108, v110, s[84:85]
    v_cndmask_b32 v108, v108, v111, s[86:87]
    v_bfe_u32 v54, v1, 3, 2
    v_cmp_eq_u32 s[82:83], 1, v54
    v_cmp_eq_u32 s[84:85], 2, v54
    v_cmp_eq_u32 s[86:87], 3, v54
    v_cndmask_b32 v96, v96, v100, s[82:83]
    v_cndmask_b32 v96, v96, v104, s[84:85]
    v_cndmask_b32 v96, v96, v108, s[86:87]
    v_mov_b32 v54, v96
    v_mov_b32 v55, v96
    s_nop 1
    v_permlane32_swap_b32 v54, v55
    v_bfe_u32 v56, v1, 2, 1
    v_cmp_eq_u32 vcc, 1, v56
    s_nop 1
    v_cndmask_b32 v35, v54, v55, vcc
    ds_write_b32 v25, v35
    s_waitcnt vmcnt(14)
    s_mov_b32 s70, 0
GR_15:
    v_cmp_ne_u32 vcc, s56, v65
    v_cmp_ne_u32 s[58:59], s56, v67
    s_nop 0
    s_or_b64 vcc, vcc, s[58:59]
    v_cmp_ne_u32 s[58:59], s56, v69
    s_nop 0
    s_or_b64 vcc, vcc, s[58:59]
    v_cmp_ne_u32 s[58:59], s56, v71
    s_nop 0
    s_or_b64 vcc, vcc, s[58:59]
    v_cmp_ne_u32 s[58:59], s56, v73
    s_nop 0
    s_or_b64 vcc, vcc, s[58:59]
    v_cmp_ne_u32 s[58:59], s56, v75
    s_nop 0
    s_or_b64 vcc, vcc, s[58:59]
    v_cmp_ne_u32 s[58:59], s56, v77
    s_nop 0
    s_or_b64 vcc, vcc, s[58:59]
    v_cmp_ne_u32 s[58:59], s56, v79
    s_nop 0
    s_or_b64 vcc, vcc, s[58:59]
    s_cmp_eq_u64 vcc, 0
    s_cbranch_scc1 GR_16
    s_add_u32 s70, s70, 1
    s_cmp_gt_u32 s70, 0x40000
    s_cbranch_scc1 GR_16
    s_sleep 1
    s_add_u32 s57, s72, 0
    buffer_load_dwordx2 v[64:65], v24, s[12:15], s57 offen sc1
    s_add_u32 s57, s72, 256
    buffer_load_dwordx2 v[66:67], v24, s[12:15], s57 offen sc1
    s_add_u32 s57, s72, 512
    buffer_load_dwordx2 v[68:69], v24, s[12:15], s57 offen sc1
    s_add_u32 s57, s72, 768
    buffer_load_dwordx2 v[70:71], v24, s[12:15], s57 offen sc1
    s_add_u32 s57, s72, 1024
    buffer_load_dwordx2 v[72:73], v24, s[12:15], s57 offen sc1
    s_add_u32 s57, s72, 1280
    buffer_load_dwordx2 v[74:75], v24, s[12:15], s57 offen sc1
    s_add_u32 s57, s72, 1536
    buffer_load_dwordx2 v[76:77], v24, s[12:15], s57 offen sc1
    s_add_u32 s57, s72, 1792
    buffer_load_dwordx2 v[78:79], v24, s[12:15], s57 offen sc1
    s_waitcnt vmcnt(0)
    s_branch GR_15
GR_16:
    v_add_f32 v64, v64, v66
    v_add_f32 v68, v68, v70
    v_add_f32 v72, v72, v74
    v_add_f32 v76, v76, v78
    v_add_f32 v64, v64, v68
    v_add_f32 v72, v72, v76
    v_add_f32 v64, v64, v72
    v_mov_b32 v65, v64
    v_mov_b32 v66, v64
    s_nop 1
    v_permlane32_swap_b32 v65, v66
    v_add_f32 v64, v65, v66
    ds_write_b32 v25, v64 offset:1792
    s_mov_b32 s70, 0
GR_17:
    v_cmp_ne_u32 vcc, s56, v81
    v_cmp_ne_u32 s[58:59], s56, v83
    s_nop 0
    s_or_b64 vcc, vcc, s[58:59]
    v_cmp_ne_u32 s[58:59], s56, v85
    s_nop 0
    s_or_b64 vcc, vcc, s[58:59]
    v_cmp_ne_u32 s[58:59], s56, v87
    s_nop 0
    s_or_b64 vcc, vcc, s[58:59]
    v_cmp_ne_u32 s[58:59], s56, v89
    s_nop 0
    s_or_b64 vcc, vcc, s[58:59]
    v_cmp_ne_u32 s[58:59], s56, v91
    s_nop 0
    s_or_b64 vcc, vcc, s[58:59]
    v_cmp_ne_u32 s[58:59], s56, v93
    s_nop 0
    s_or_b64 vcc, vcc, s[58:59]
    v_cmp_ne_u32 s[58:59], s56, v95
    s_nop 0
    s_or_b64 vcc, vcc, s[58:59]
    s_cmp_eq_u64 vcc, 0
    s_cbranch_scc1 GR_18
    s_add_u32 s70, s70, 1
    s_cmp_gt_u32 s70, 0x40000
    s_cbranch_scc1 GR_18
    s_sleep 1
    s_add_u32 s57, s73, 0
    buffer_load_dwordx2 v[80:81], v24, s[12:15], s57 offen sc1
    s_add_u32 s57, s73, 256
    buffer_load_dwordx2 v[82:83], v24, s[12:15], s57 offen sc1
    s_add_u32 s57, s73, 512
    buffer_load_dwordx2 v[84:85], v24, s[12:15], s57 offen sc1
    s_add_u32 s57, s73, 768
    buffer_load_dwordx2 v[86:87], v24, s[12:15], s57 offen sc1
    s_add_u32 s57, s73, 1024
    buffer_load_dwordx2 v[88:89], v24, s[12:15], s57 offen sc1
    s_add_u32 s57, s73, 1280
    buffer_load_dwordx2 v[90:91], v24, s[12:15], s57 offen sc1
    s_add_u32 s57, s73, 1536
    buffer_load_dwordx2 v[92:93], v24, s[12:15], s57 offen sc1
    s_add_u32 s57, s73, 1792
    buffer_load_dwordx2 v[94:95], v24, s[12:15], s57 offen sc1
    s_waitcnt vmcnt(0)
    s_branch GR_17
GR_18:
    v_add_f32 v80, v80, v82
    v_add_f32 v84, v84, v86
    v_add_f32 v88, v88, v90
    v_add_f32 v92, v92, v94
    v_add_f32 v80, v80, v84
    v_add_f32 v88, v88, v92
    v_add_f32 v80, v80, v88
    v_mov_b32 v81, v80
    v_mov_b32 v82, v80
    s_nop 1
    v_permlane32_swap_b32 v81, v82
    v_add_f32 v80, v81, v82
    v_cmp_gt_u32 vcc, 32, v1
    v_cvt_pk_bf16_f32 v81, v80, v80
    v_and_b32 v81, 0xffff0000, v81
    v_sub_f32 v82, v80, v81
    v_cvt_pk_bf16_f32 v84, v81, v82
    v_cndmask_b32 v84, 0, v84, vcc
    v_mov_b32 v85, v84
    v_lshl_or_b32 v86, v112, 16, v112
    v_cndmask_b32 v86, 0, v86, vcc
    v_mov_b32 v87, 0
    s_lshl_b32 s57, s22, 10
    s_add_u32 s57, s57, 142336
    v_add_u32 v26, s57, v6
    ds_write_b128 v26, v[84:87]
    s_waitcnt lgkmcnt(0)
    s_barrier
    ds_read_b32 v34, v25 offset:512
    s_waitcnt lgkmcnt(0)
    v_mul_f32 v34, 0x3b124925, v34
    v_mul_f32 v35, 0x3b124925, v35
    v_fma_f32 v35, -v34, v34, v35
    v_max_f32 v35, 0, v35
    v_add_f32 v35, 0x3727c5ac, v35
    v_rsq_f32 v32, v35
    s_nop 0
    v_mul_f32 v33, v35, v32
    v_cvt_pk_bf16_f32 v54, v34, v34
    v_and_b32 v54, 0xffff0000, v54
    v_sub_f32 v55, v34, v54
    v_cvt_pk_bf16_f32 v28, -v54, -v54
    v_cvt_pk_bf16_f32 v29, -v55, -v55
    v_cvt_pk_bf16_f32 v54, v33, v33
    v_and_b32 v54, 0xffff0000, v54
    v_sub_f32 v55, v33, v54
    v_cvt_pk_bf16_f32 v30, v54, v55
    v_cmp_gt_u32 vcc, 32, v1
    s_nop 1
    v_cndmask_b32 v28, 0, v28, vcc
    v_cndmask_b32 v29, 0, v29, vcc
    v_cndmask_b32 v30, 0, v30, vcc
    v_mov_b32 v31, 0
    v_mul_f32 v243, 0xc0135761, v32
    v_mul_f32 v244, v32, v32
    v_mul_f32 v244, v244, v32
    v_mul_f32 v244, 0xbdd2d3e8, v244
    v_mov_b32 v245, v33
    s_mul_i32 s64, s71, 112*1024
    s_add_u32 s64, s64, 6291456
    s_waitcnt vmcnt(0)
    v_mov_b32 v56, 155672
    v_mov_b32 v57, 1
    s_mov_b64 s[58:59], exec
    s_mov_b64 exec, 1
    ds_add_u32 v56, v57
    s_mov_b64 exec, s[58:59]
    v_mov_b32 v56, 155668
    v_mov_b32 v57, 1
    s_mov_b64 s[58:59], exec
    s_mov_b64 exec, 1
    ds_add_u32 v56, v57
    s_mov_b64 exec, s[58:59]
    ds_read_b64_tr_b16 v[40:41], v20 offset:0
    ds_read_b64_tr_b16 v[42:43], v20 offset:256
    ds_read_b64_tr_b16 v[44:45], v20 offset:1024
    ds_read_b64_tr_b16 v[46:47], v20 offset:1280
    ds_read_b64_tr_b16 v[48:49], v20 offset:2048
    ds_read_b64_tr_b16 v[50:51], v20 offset:2304
    ds_read_b64_tr_b16 v[52:53], v20 offset:3072
    ds_read_b64_tr_b16 v[54:55], v20 offset:3328
    ds_read_b64_tr_b16 v[56:57], v20 offset:4096
    ds_read_b64_tr_b16 v[58:59], v20 offset:4352
    ds_read_b64_tr_b16 v[60:61], v20 offset:5120
    ds_read_b64_tr_b16 v[62:63], v20 offset:5376
    s_waitcnt lgkmcnt(10)
    v_mfma_f32_32x32x16_bf16 v[64:79], v[40:43], v[128:131], 0
    s_add_u32 m0, s35, 98304
    s_add_u32 s67, s66, s63
    buffer_load_dwordx4 v7, s[16:19], s67 offen lds
    ds_read_b64_tr_b16 v[40:41], v20 offset:6144
    ds_read_b64_tr_b16 v[42:43], v20 offset:6400
    s_waitcnt lgkmcnt(10)
    v_mfma_f32_32x32x16_bf16 v[64:79], v[44:47], v[132:135], v[64:79]
    s_add_u32 m0, s35, 99328
    s_add_u32 s67, s67, 57344
    buffer_load_dwordx4 v7, s[16:19], s67 offen lds
    ds_read_b64_tr_b16 v[44:45], v20 offset:7168
    ds_read_b64_tr_b16 v[46:47], v20 offset:7424
    s_waitcnt lgkmcnt(10)
    v_mfma_f32_32x32x16_bf16 v[64:79], v[48:51], v[136:139], v[64:79]
    s_add_u32 m0, s35, 100352
    s_add_u32 s67, s67, 57344
    buffer_load_dwordx4 v7, s[16:19], s67 offen lds
    ds_read_b64_tr_b16 v[48:49], v20 offset:8192
    ds_read_b64_tr_b16 v[50:51], v20 offset:8448
    s_waitcnt lgkmcnt(10)
    v_mfma_f32_32x32x16_bf16 v[64:79], v[52:55], v[140:143], v[64:79]
    s_add_u32 m0, s35, 101376
    s_add_u32 s67, s67, 57344
    buffer_load_dwordx4 v7, s[16:19], s67 offen lds
    ds_read_b64_tr_b16 v[52:53], v20 offset:9216
    ds_read_b64_tr_b16 v[54:55], v20 offset:9472
    s_waitcnt lgkmcnt(10)
    v_mfma_f32_32x32x16_bf16 v[64:79], v[56:59], v[144:147], v[64:79]
    s_add_u32 m0, s35, 102400
    s_add_u32 s67, s67, 57344
    buffer_load_dwordx4 v7, s[16:19], s67 offen lds
    ds_read_b64_tr_b16 v[56:57], v20 offset:10240
    ds_read_b64_tr_b16 v[58:59], v20 offset:10496
    s_waitcnt lgkmcnt(10)
    v_mfma_f32_32x32x16_bf16 v[64:79], v[60:63], v[148:151], v[64:79]
    s_add_u32 m0, s35, 103424
    s_add_u32 s67, s67, 57344
    buffer_load_dwordx4 v7, s[16:19], s67 offen lds
    ds_read_b64_tr_b16 v[60:61], v20 offset:11264
    ds_read_b64_tr_b16 v[62:63], v20 offset:11520
    s_waitcnt lgkmcnt(10)
    v_mfma_f32_32x32x16_bf16 v[64:79], v[40:43], v[152:155], v[64:79]
    s_add_u32 m0, s35, 104448
    s_add_u32 s67, s67, 57344
    buffer_load_dwordx4 v7, s[16:19], s67 offen lds
    ds_read_b64_tr_b16 v[40:41], v20 offset:12288
    ds_read_b64_tr_b16 v[42:43], v20 offset:12544
    s_waitcnt lgkmcnt(10)
    v_mfma_f32_32x32x16_bf16 v[64:79], v[44:47], v[156:159], v[64:79]
    ds_read_b64_tr_b16 v[44:45], v20 offset:13312
    ds_read_b64_tr_b16 v[46:47], v20 offset:13568
    s_waitcnt lgkmcnt(10)
    v_mfma_f32_32x32x16_bf16 v[64:79], v[48:51], v[160:163], v[64:79]
    ds_read_b64_tr_b16 v[48:49], v20 offset:14336
    ds_read_b64_tr_b16 v[50:51], v20 offset:14592
    s_waitcnt lgkmcnt(10)
    v_mfma_f32_32x32x16_bf16 v[64:79], v[52:55], v[164:167], v[64:79]
    ds_read_b64_tr_b16 v[52:53], v20 offset:15360
    ds_read_b64_tr_b16 v[54:55], v20 offset:15616
    s_waitcnt lgkmcnt(10)
    v_mfma_f32_32x32x16_bf16 v[64:79], v[56:59], v[168:171], v[64:79]
    ds_read_b64_tr_b16 v[56:57], v20 offset:16384
    ds_read_b64_tr_b16 v[58:59], v20 offset:16640
    s_waitcnt lgkmcnt(10)
    v_mfma_f32_32x32x16_bf16 v[64:79], v[60:63], v[172:175], v[64:79]
    ds_read_b64_tr_b16 v[60:61], v20 offset:17408
    ds_read_b64_tr_b16 v[62:63], v20 offset:17664
    s_waitcnt lgkmcnt(10)
    v_mfma_f32_32x32x16_bf16 v[64:79], v[40:43], v[176:179], v[64:79]
    ds_read_b64_tr_b16 v[40:41], v20 offset:18432
    ds_read_b64_tr_b16 v[42:43], v20 offset:18688
    s_waitcnt lgkmcnt(10)
    v_mfma_f32_32x32x16_bf16 v[64:79], v[44:47], v[180:183], v[64:79]
    ds_read_b64_tr_b16 v[44:45], v20 offset:19456
    ds_read_b64_tr_b16 v[46:47], v20 offset:19712
    s_waitcnt lgkmcnt(10)
    v_mfma_f32_32x32x16_bf16 v[64:79], v[48:51], v[184:187], v[64:79]
    ds_read_b64_tr_b16 v[48:49], v20 offset:20480
    ds_read_b64_tr_b16 v[50:51], v20 offset:20736
    s_waitcnt lgkmcnt(10)
    v_mfma_f32_32x32x16_bf16 v[64:79], v[52:55], v[188:191], v[64:79]
    ds_read_b64_tr_b16 v[52:53], v20 offset:21504
    ds_read_b64_tr_b16 v[54:55], v20 offset:21760
    s_waitcnt lgkmcnt(10)
    v_mfma_f32_32x32x16_bf16 v[64:79], v[56:59], v[192:195], v[64:79]
    ds_read_b64_tr_b16 v[56:57], v20 offset:22528
    ds_read_b64_tr_b16 v[58:59], v20 offset:22784
    s_waitcnt lgkmcnt(10)
    v_mfma_f32_32x32x16_bf16 v[64:79], v[60:63], v[196:199], v[64:79]
    ds_read_b64_tr_b16 v[60:61], v20 offset:23552
    ds_read_b64_tr_b16 v[62:63], v20 offset:23808
    s_waitcnt lgkmcnt(10)
    v_mfma_f32_32x32x16_bf16 v[64:79], v[40:43], v[200:203], v[64:79]
    ds_read_b64_tr_b16 v[40:41], v20 offset:24576
    ds_read_b64_tr_b16 v[42:43], v20 offset:24832
    s_waitcnt lgkmcnt(10)
    v_mfma_f32_32x32x16_bf16 v[64:79], v[44:47], v[204:207], v[64:79]
    ds_read_b64_tr_b16 v[44:45], v20 offset:25600
    ds_read_b64_tr_b16 v[46:47], v20 offset:25856
    s_waitcnt lgkmcnt(10)
    v_mfma_f32_32x32x16_bf16 v[64:79], v[48:51], v[208:211], v[64:79]
    ds_read_b64_tr_b16 v[48:49], v20 offset:26624
    ds_read_b64_tr_b16 v[50:51], v20 offset:26880
    s_waitcnt lgkmcnt(10)
    v_mfma_f32_32x32x16_bf16 v[64:79], v[52:55], v[212:215], v[64:79]
    ds_read_b64_tr_b16 v[52:53], v20 offset:27648
    ds_read_b64_tr_b16 v[54:55], v20 offset:27904
    s_waitcnt lgkmcnt(10)
    v_mfma_f32_32x32x16_bf16 v[64:79], v[56:59], v[216:219], v[64:79]
    s_waitcnt lgkmcnt(8)
    v_mfma_f32_32x32x16_bf16 v[64:79], v[60:63], v[220:223], v[64:79]
    s_waitcnt lgkmcnt(6)
    v_mfma_f32_32x32x16_bf16 v[64:79], v[40:43], v[224:227], v[64:79]
    s_waitcnt lgkmcnt(4)
    v_mfma_f32_32x32x16_bf16 v[64:79], v[44:47], v[228:231], v[64:79]
    s_waitcnt lgkmcnt(2)
    v_mfma_f32_32x32x16_bf16 v[64:79], v[48:51], v[232:235], v[64:79]
    s_waitcnt lgkmcnt(0)
    v_mfma_f32_32x32x16_bf16 v[64:79], v[52:55], v[236:239], v[64:79]
    v_mov_b32 v56, 155664
    v_mov_b32 v57, 1
    s_mov_b64 s[58:59], exec
    s_mov_b64 exec, 1
    ds_add_u32 v56, v57
    s_mov_b64 exec, s[58:59]
    v_add_u32 v25, 142336, v6
    ds_read_b128 v[36:39], v25
    s_waitcnt lgkmcnt(0)
    v_mfma_f32_32x32x16_bf16 v[64:79], v[36:39], v[28:31], v[64:79]
    s_waitcnt vmcnt(0)
    v_mov_b32 v56, 155676
    v_mov_b32 v57, 1
    s_mov_b64 s[58:59], exec
    s_mov_b64 exec, 1
    ds_add_u32 v56, v57
    s_mov_b64 exec, s[58:59]
    v_mov_b32 v24, 155668
LW_19:
    ds_read_b32 v25, v24
    s_waitcnt lgkmcnt(0)
    v_readfirstlane_b32 s57, v25
    s_nop 0
    s_cmp_ge_u32 s57, 4
    s_cbranch_scc0 LW_19
    ds_read_b64_tr_b16 v[40:41], v20 offset:32768
    ds_read_b64_tr_b16 v[42:43], v20 offset:33024
    ds_read_b64_tr_b16 v[44:45], v20 offset:33792
    ds_read_b64_tr_b16 v[46:47], v20 offset:34048
    ds_read_b64_tr_b16 v[48:49], v20 offset:34816
    ds_read_b64_tr_b16 v[50:51], v20 offset:35072
    ds_read_b64_tr_b16 v[52:53], v20 offset:35840
    ds_read_b64_tr_b16 v[54:55], v20 offset:36096
    ds_read_b64_tr_b16 v[56:57], v20 offset:36864
    ds_read_b64_tr_b16 v[58:59], v20 offset:37120
    ds_read_b64_tr_b16 v[60:61], v20 offset:37888
    ds_read_b64_tr_b16 v[62:63], v20 offset:38144
    s_waitcnt lgkmcnt(10)
    v_mfma_f32_32x32x16_bf16 v[80:95], v[40:43], v[128:131], 0
    v_mul_f32 v96, v64, v64
    v_mul_f32 v97, v65, v65
    v_mul_f32 v98, v66, v66
    v_mul_f32 v99, v67, v67
    v_mul_f32 v100, v68, v68
    ds_read_b64_tr_b16 v[40:41], v20 offset:38912
    ds_read_b64_tr_b16 v[42:43], v20 offset:39168
    s_waitcnt lgkmcnt(10)
    v_mfma_f32_32x32x16_bf16 v[80:95], v[44:47], v[132:135], v[80:95]
    v_mul_f32 v101, v69, v69
    v_mul_f32 v102, v70, v70
    v_mul_f32 v103, v71, v71
    v_fma_f32 v96, v96, v244, v243
    v_fma_f32 v97, v97, v244, v243
    ds_read_b64_tr_b16 v[44:45], v20 offset:39936
    ds_read_b64_tr_b16 v[46:47], v20 offset:40192
    s_waitcnt lgkmcnt(10)
    v_mfma_f32_32x32x16_bf16 v[80:95], v[48:51], v[136:139], v[80:95]
    v_fma_f32 v98, v98, v244, v243
    v_fma_f32 v99, v99, v244, v243
    v_fma_f32 v100, v100, v244, v243
    v_fma_f32 v101, v101, v244, v243
    v_fma_f32 v102, v102, v244, v243
    ds_read_b64_tr_b16 v[48:49], v20 offset:40960
    ds_read_b64_tr_b16 v[50:51], v20 offset:41216
    s_waitcnt lgkmcnt(10)
    v_mfma_f32_32x32x16_bf16 v[80:95], v[52:55], v[140:143], v[80:95]
    v_fma_f32 v103, v103, v244, v243
    v_mul_f32 v96, v96, v64
    v_mul_f32 v97, v97, v65
    v_mul_f32 v98, v98, v66
    v_mul_f32 v99, v99, v67
    ds_read_b64_tr_b16 v[52:53], v20 offset:41984
    ds_read_b64_tr_b16 v[54:55], v20 offset:42240
    s_waitcnt lgkmcnt(10)
    v_mfma_f32_32x32x16_bf16 v[80:95], v[56:59], v[144:147], v[80:95]
    v_mul_f32 v100, v100, v68
    v_mul_f32 v101, v101, v69
    v_mul_f32 v102, v102, v70
    v_mul_f32 v103, v103, v71
    v_exp_f32 v96, v96
    ds_read_b64_tr_b16 v[56:57], v20 offset:43008
    ds_read_b64_tr_b16 v[58:59], v20 offset:43264
    s_waitcnt lgkmcnt(10)
    v_mfma_f32_32x32x16_bf16 v[80:95], v[60:63], v[148:151], v[80:95]
    v_exp_f32 v97, v97
    v_exp_f32 v98, v98
    v_exp_f32 v99, v99
    v_exp_f32 v100, v100
    v_exp_f32 v101, v101
    ds_read_b64_tr_b16 v[60:61], v20 offset:44032
    ds_read_b64_tr_b16 v[62:63], v20 offset:44288
    s_waitcnt lgkmcnt(10)
    v_mfma_f32_32x32x16_bf16 v[80:95], v[40:43], v[152:155], v[80:95]
    v_exp_f32 v102, v102
    v_exp_f32 v103, v103
    v_fma_f32 v96, v96, v245, v245
    v_fma_f32 v97, v97, v245, v245
    v_fma_f32 v98, v98, v245, v245
    ds_read_b64_tr_b16 v[40:41], v20 offset:45056
    ds_read_b64_tr_b16 v[42:43], v20 offset:45312
    s_waitcnt lgkmcnt(10)
    v_mfma_f32_32x32x16_bf16 v[80:95], v[44:47], v[156:159], v[80:95]
    v_fma_f32 v99, v99, v245, v245
    v_fma_f32 v100, v100, v245, v245
    v_fma_f32 v101, v101, v245, v245
    v_fma_f32 v102, v102, v245, v245
    v_fma_f32 v103, v103, v245, v245
    ds_read_b64_tr_b16 v[44:45], v20 offset:46080
    ds_read_b64_tr_b16 v[46:47], v20 offset:46336
    s_waitcnt lgkmcnt(10)
    v_mfma_f32_32x32x16_bf16 v[80:95], v[48:51], v[160:163], v[80:95]
    v_rcp_f32 v96, v96
    v_rcp_f32 v97, v97
    v_rcp_f32 v98, v98
    v_rcp_f32 v99, v99
    v_rcp_f32 v100, v100
    ds_read_b64_tr_b16 v[48:49], v20 offset:47104
    ds_read_b64_tr_b16 v[50:51], v20 offset:47360
    s_waitcnt lgkmcnt(10)
    v_mfma_f32_32x32x16_bf16 v[80:95], v[52:55], v[164:167], v[80:95]
    v_rcp_f32 v101, v101
    v_rcp_f32 v102, v102
    v_rcp_f32 v103, v103
    v_mul_f32 v96, v96, v64
    v_mul_f32 v97, v97, v65
    ds_read_b64_tr_b16 v[52:53], v20 offset:48128
    ds_read_b64_tr_b16 v[54:55], v20 offset:48384
    s_waitcnt lgkmcnt(10)
    v_mfma_f32_32x32x16_bf16 v[80:95], v[56:59], v[168:171], v[80:95]
    v_mul_f32 v98, v98, v66
    v_mul_f32 v99, v99, v67
    v_mul_f32 v100, v100, v68
    v_mul_f32 v101, v101, v69
    v_mul_f32 v102, v102, v70
    ds_read_b64_tr_b16 v[56:57], v20 offset:49152
    ds_read_b64_tr_b16 v[58:59], v20 offset:49408
    s_waitcnt lgkmcnt(10)
    v_mfma_f32_32x32x16_bf16 v[80:95], v[60:63], v[172:175], v[80:95]
    v_mul_f32 v103, v103, v71
    v_mul_f32 v104, v72, v72
    v_mul_f32 v105, v73, v73
    v_mul_f32 v106, v74, v74
    v_mul_f32 v107, v75, v75
    ds_read_b64_tr_b16 v[60:61], v20 offset:50176
    ds_read_b64_tr_b16 v[62:63], v20 offset:50432
    s_waitcnt lgkmcnt(10)
    v_mfma_f32_32x32x16_bf16 v[80:95], v[40:43], v[176:179], v[80:95]
    v_mul_f32 v108, v76, v76
    v_mul_f32 v109, v77, v77
    v_mul_f32 v110, v78, v78
    v_mul_f32 v111, v79, v79
    v_fma_f32 v104, v104, v244, v243
    ds_read_b64_tr_b16 v[40:41], v20 offset:51200
    ds_read_b64_tr_b16 v[42:43], v20 offset:51456
    s_waitcnt lgkmcnt(10)
    v_mfma_f32_32x32x16_bf16 v[80:95], v[44:47], v[180:183], v[80:95]
    v_fma_f32 v105, v105, v244, v243
    v_fma_f32 v106, v106, v244, v243
    v_fma_f32 v107, v107, v244, v243
    v_fma_f32 v108, v108, v244, v243
    v_fma_f32 v109, v109, v244, v243
    ds_read_b64_tr_b16 v[44:45], v20 offset:52224
    ds_read_b64_tr_b16 v[46:47], v20 offset:52480
    s_waitcnt lgkmcnt(10)
    v_mfma_f32_32x32x16_bf16 v[80:95], v[48:51], v[184:187], v[80:95]
    v_fma_f32 v110, v110, v244, v243
    v_fma_f32 v111, v111, v244, v243
    v_mul_f32 v104, v104, v72
    v_mul_f32 v105, v105, v73
    v_mul_f32 v106, v106, v74
    ds_read_b64_tr_b16 v[48:49], v20 offset:53248
    ds_read_b64_tr_b16 v[50:51], v20 offset:53504
    s_waitcnt lgkmcnt(10)
    v_mfma_f32_32x32x16_bf16 v[80:95], v[52:55], v[188:191], v[80:95]
    v_mul_f32 v107, v107, v75
    v_mul_f32 v108, v108, v76
    v_mul_f32 v109, v109, v77
    v_mul_f32 v110, v110, v78
    v_mul_f32 v111, v111, v79
    ds_read_b64_tr_b16 v[52:53], v20 offset:54272
    ds_read_b64_tr_b16 v[54:55], v20 offset:54528
    s_waitcnt lgkmcnt(10)
    v_mfma_f32_32x32x16_bf16 v[80:95], v[56:59], v[192:195], v[80:95]
    v_exp_f32 v104, v104
    v_exp_f32 v105, v105
    v_exp_f32 v106, v106
    v_exp_f32 v107, v107
    v_exp_f32 v108, v108
    ds_read_b64_tr_b16 v[56:57], v20 offset:55296
    ds_read_b64_tr_b16 v[58:59], v20 offset:55552
    s_waitcnt lgkmcnt(10)
    v_mfma_f32_32x32x16_bf16 v[80:95], v[60:63], v[196:199], v[80:95]
    v_exp_f32 v109, v109
    v_exp_f32 v110, v110
    v_exp_f32 v111, v111
    v_fma_f32 v104, v104, v245, v245
    v_fma_f32 v105, v105, v245, v245
    ds_read_b64_tr_b16 v[60:61], v20 offset:56320
    ds_read_b64_tr_b16 v[62:63], v20 offset:56576
    s_waitcnt lgkmcnt(10)
    v_mfma_f32_32x32x16_bf16 v[80:95], v[40:43], v[200:203], v[80:95]
    v_fma_f32 v106, v106, v245, v245
    v_fma_f32 v107, v107, v245, v245
    v_fma_f32 v108, v108, v245, v245
    v_fma_f32 v109, v109, v245, v245
    v_fma_f32 v110, v110, v245, v245
    ds_read_b64_tr_b16 v[40:41], v20 offset:57344
    ds_read_b64_tr_b16 v[42:43], v20 offset:57600
    s_waitcnt lgkmcnt(10)
    v_mfma_f32_32x32x16_bf16 v[80:95], v[44:47], v[204:207], v[80:95]
    v_fma_f32 v111, v111, v245, v245
    v_rcp_f32 v104, v104
    v_rcp_f32 v105, v105
    v_rcp_f32 v106, v106
    v_rcp_f32 v107, v107
    ds_read_b64_tr_b16 v[44:45], v20 offset:58368
    ds_read_b64_tr_b16 v[46:47], v20 offset:58624
    s_waitcnt lgkmcnt(10)
    v_mfma_f32_32x32x16_bf16 v[80:95], v[48:51], v[208:211], v[80:95]
    v_rcp_f32 v108, v108
    v_rcp_f32 v109, v109
    v_rcp_f32 v110, v110
    v_rcp_f32 v111, v111
    v_mul_f32 v104, v104, v72
    ds_read_b64_tr_b16 v[48:49], v20 offset:59392
    ds_read_b64_tr_b16 v[50:51], v20 offset:59648
    s_waitcnt lgkmcnt(10)
    v_mfma_f32_32x32x16_bf16 v[80:95], v[52:55], v[212:215], v[80:95]
    v_mul_f32 v105, v105, v73
    v_mul_f32 v106, v106, v74
    v_mul_f32 v107, v107, v75
    v_mul_f32 v108, v108, v76
    v_mul_f32 v109, v109, v77
    ds_read_b64_tr_b16 v[52:53], v20 offset:60416
    ds_read_b64_tr_b16 v[54:55], v20 offset:60672
    s_waitcnt lgkmcnt(10)
    v_mfma_f32_32x32x16_bf16 v[80:95], v[56:59], v[216:219], v[80:95]
    v_mul_f32 v110, v110, v78
    v_mul_f32 v111, v111, v79
    v_cvt_pk_bf16_f32 v112, v96, v97
    v_cvt_pk_bf16_f32 v113, v98, v99
    v_cvt_pk_bf16_f32 v114, v100, v101
    s_waitcnt lgkmcnt(8)
    v_mfma_f32_32x32x16_bf16 v[80:95], v[60:63], v[220:223], v[80:95]
    v_cvt_pk_bf16_f32 v115, v102, v103
    v_cvt_pk_bf16_f32 v116, v104, v105
    v_cvt_pk_bf16_f32 v117, v106, v107
    v_cvt_pk_bf16_f32 v118, v108, v109
    v_cvt_pk_bf16_f32 v119, v110, v111
    s_waitcnt lgkmcnt(6)
    v_mfma_f32_32x32x16_bf16 v[80:95], v[40:43], v[224:227], v[80:95]
    s_lshl_b32 s67, s60, 5
    s_add_u32 s67, s67, s64
    buffer_store_dwordx4 v[112:115], v6, s[12:15], s67 offen sc1
    buffer_store_dwordx4 v[116:119], v6, s[12:15], s67 offen offset:1024 sc1
    s_waitcnt lgkmcnt(4)
    v_mfma_f32_32x32x16_bf16 v[80:95], v[44:47], v[228:231], v[80:95]
    s_waitcnt lgkmcnt(2)
    v_mfma_f32_32x32x16_bf16 v[80:95], v[48:51], v[232:235], v[80:95]
    s_waitcnt lgkmcnt(0)
    v_mfma_f32_32x32x16_bf16 v[80:95], v[52:55], v[236:239], v[80:95]
    v_add_u32 v25, 143360, v6
    ds_read_b128 v[36:39], v25
    s_waitcnt lgkmcnt(0)
    v_mfma_f32_32x32x16_bf16 v[80:95], v[36:39], v[28:31], v[80:95]
    s_nop 11
    v_mul_f32 v96, v80, v80
    v_mul_f32 v97, v81, v81
    v_mul_f32 v98, v82, v82
    v_mul_f32 v99, v83, v83
    v_mul_f32 v100, v84, v84
    v_mul_f32 v101, v85, v85
    v_mul_f32 v102, v86, v86
    v_mul_f32 v103, v87, v87
    v_fma_f32 v96, v96, v244, v243
    v_fma_f32 v97, v97, v244, v243
    v_fma_f32 v98, v98, v244, v243
    v_fma_f32 v99, v99, v244, v243
    v_fma_f32 v100, v100, v244, v243
    v_fma_f32 v101, v101, v244, v243
    v_fma_f32 v102, v102, v244, v243
    v_fma_f32 v103, v103, v244, v243
    v_mul_f32 v96, v96, v80
    v_mul_f32 v97, v97, v81
    v_mul_f32 v98, v98, v82
    v_mul_f32 v99, v99, v83
    v_mul_f32 v100, v100, v84
    v_mul_f32 v101, v101, v85
    v_mul_f32 v102, v102, v86
    v_mul_f32 v103, v103, v87
    v_exp_f32 v96, v96
    v_exp_f32 v97, v97
    v_exp_f32 v98, v98
    v_exp_f32 v99, v99
    v_exp_f32 v100, v100
    v_exp_f32 v101, v101
    v_exp_f32 v102, v102
    v_exp_f32 v103, v103
    v_fma_f32 v96, v96, v245, v245
    v_fma_f32 v97, v97, v245, v245
    v_fma_f32 v98, v98, v245, v245
    v_fma_f32 v99, v99, v245, v245
    v_fma_f32 v100, v100, v245, v245
    v_fma_f32 v101, v101, v245, v245
    v_fma_f32 v102, v102, v245, v245
    v_fma_f32 v103, v103, v245, v245
    v_rcp_f32 v96, v96
    v_rcp_f32 v97, v97
    v_rcp_f32 v98, v98
    v_rcp_f32 v99, v99
    v_rcp_f32 v100, v100
    v_rcp_f32 v101, v101
    v_rcp_f32 v102, v102
    v_rcp_f32 v103, v103
    v_mul_f32 v96, v96, v80
    v_mul_f32 v97, v97, v81
    v_mul_f32 v98, v98, v82
    v_mul_f32 v99, v99, v83
    v_mul_f32 v100, v100, v84
    v_mul_f32 v101, v101, v85
    v_mul_f32 v102, v102, v86
    v_mul_f32 v103, v103, v87
    v_mul_f32 v104, v88, v88
    v_mul_f32 v105, v89, v89
    v_mul_f32 v106, v90, v90
    v_mul_f32 v107, v91, v91
    v_mul_f32 v108, v92, v92
    v_mul_f32 v109, v93, v93
    v_mul_f32 v110, v94, v94
    v_mul_f32 v111, v95, v95
    v_fma_f32 v104, v104, v244, v243
    v_fma_f32 v105, v105, v244, v243
    v_fma_f32 v106, v106, v244, v243
    v_fma_f32 v107, v107, v244, v243
    v_fma_f32 v108, v108, v244, v243
    v_fma_f32 v109, v109, v244, v243
    v_fma_f32 v110, v110, v244, v243
    v_fma_f32 v111, v111, v244, v243
    v_mul_f32 v104, v104, v88
    v_mul_f32 v105, v105, v89
    v_mul_f32 v106, v106, v90
    v_mul_f32 v107, v107, v91
    v_mul_f32 v108, v108, v92
    v_mul_f32 v109, v109, v93
    v_mul_f32 v110, v110, v94
    v_mul_f32 v111, v111, v95
    v_exp_f32 v104, v104
    v_exp_f32 v105, v105
    v_exp_f32 v106, v106
    v_exp_f32 v107, v107
    v_exp_f32 v108, v108
    v_exp_f32 v109, v109
    v_exp_f32 v110, v110
    v_exp_f32 v111, v111
    v_fma_f32 v104, v104, v245, v245
    v_fma_f32 v105, v105, v245, v245
    v_fma_f32 v106, v106, v245, v245
    v_fma_f32 v107, v107, v245, v245
    v_fma_f32 v108, v108, v245, v245
    v_fma_f32 v109, v109, v245, v245
    v_fma_f32 v110, v110, v245, v245
    v_fma_f32 v111, v111, v245, v245
    v_rcp_f32 v104, v104
    v_rcp_f32 v105, v105
    v_rcp_f32 v106, v106
    v_rcp_f32 v107, v107
    v_rcp_f32 v108, v108
    v_rcp_f32 v109, v109
    v_rcp_f32 v110, v110
    v_rcp_f32 v111, v111
    v_mul_f32 v104, v104, v88
    v_mul_f32 v105, v105, v89
    v_mul_f32 v106, v106, v90
    v_mul_f32 v107, v107, v91
    v_mul_f32 v108, v108, v92
    v_mul_f32 v109, v109, v93
    v_mul_f32 v110, v110, v94
    v_mul_f32 v111, v111, v95
    v_cvt_pk_bf16_f32 v120, v96, v97
    v_cvt_pk_bf16_f32 v121, v98, v99
    v_cvt_pk_bf16_f32 v122, v100, v101
    v_cvt_pk_bf16_f32 v123, v102, v103
    v_cvt_pk_bf16_f32 v124, v104, v105
    v_cvt_pk_bf16_f32 v125, v106, v107
    v_cvt_pk_bf16_f32 v126, v108, v109
    v_cvt_pk_bf16_f32 v127, v110, v111
    s_lshl_b32 s67, s61, 5
    s_add_u32 s67, s67, s64
    buffer_store_dwordx4 v[120:123], v6, s[12:15], s67 offen sc1
    buffer_store_dwordx4 v[124:127], v6, s[12:15], s67 offen offset:1024 sc1
    s_add_u32 s80, s21, 16
    s_mul_i32 s80, s80, 171
    s_lshr_b32 s80, s80, 9
    s_add_u32 s81, s21, 32
    s_mul_i32 s81, s81, 171
    s_lshr_b32 s81, s81, 9
    s_mul_i32 s82, s21, 171
    s_lshr_b32 s82, s82, 9
    s_lshl_b32 s80, s80, 8
    s_lshl_b32 s81, s81, 8
    s_lshl_b32 s82, s82, 8
    s_lshl_b32 s57, s20, 2
    s_add_u32 s82, s82, s57
    v_and_b32 v24, 15, v1
    v_lshlrev_b32 v24, 2, v24
    v_add_u32 v25, s80, v24
    v_add_u32 v26, s81, v24
    v_mov_b32 v27, s82
    v_cmp_gt_u32 vcc, 16, v1
    s_nop 1
    v_cndmask_b32 v24, v26, v25, vcc
    v_cmp_gt_u32 vcc, 32, v1
    s_nop 1
    v_cndmask_b32 v24, v27, v24, vcc
    v_add_u32 v24, 17309696, v24
    s_mov_b32 s57, 0
POLL_20:
    buffer_load_dword v25, v24, s[12:15], 0 offen sc0 sc1
    s_waitcnt vmcnt(0)
POLLC_22:
    v_cmp_ne_u32 vcc, s56, v25
    s_nop 1
    s_cmp_eq_u64 vcc, 0
    s_cbranch_scc1 POLLD_21
    s_add_u32 s57, s57, 1
    s_cmp_gt_u32 s57, 0x40000
    s_cbranch_scc1 POLLD_21
    s_sleep 1
    s_branch POLL_20
POLLD_21:
    v_mov_b32 v24, 155664
LW_23:
    ds_read_b32 v25, v24
    s_waitcnt lgkmcnt(0)
    v_readfirstlane_b32 s57, v25
    s_nop 0
    s_cmp_ge_u32 s57, 4
    s_cbranch_scc0 LW_23
    s_lshl_b32 s24, s21, 6
    s_lshr_b32 s57, s22, 1
    s_lshl_b32 s57, s57, 5
    s_add_u32 s24, s24, s57
    s_and_b32 s57, s22, 1
    s_add_u32 s24, s24, s57
    s_lshl_b32 s24, s24, 12
    s_add_u32 s24, s24, 2097152
    s_lshl_b32 s25, s22, 12
    s_lshl_b32 s57, s21, 6
    s_add_u32 s57, s57, s71
    s_lshl_b32 s57, s57, 11
    s_lshl_b32 s70, s22, 11
    s_add_u32 m0, s70, 147456
    s_nop 0
    buffer_load_dwordx4 v6, s[12:15], s57 offen sc1 lds
    buffer_load_dwordx4 v6, s[12:15], s57 offen offset:1024 sc1 lds
    s_add_u32 m0, s25, 0
    s_nop 0
    buffer_load_dwordx4 v6, s[12:15], s24 offen offset:0 sc1 lds
    buffer_load_dwordx4 v6, s[12:15], s24 offen offset:1024 sc1 lds
    buffer_load_dwordx4 v6, s[12:15], s24 offen offset:2048 sc1 lds
    buffer_load_dwordx4 v6, s[12:15], s24 offen offset:3072 sc1 lds
    s_add_u32 s24, s24, 8192
    s_add_u32 m0, s25, 16384
    s_nop 0
    buffer_load_dwordx4 v6, s[12:15], s24 offen offset:0 sc1 lds
    buffer_load_dwordx4 v6, s[12:15], s24 offen offset:1024 sc1 lds
    buffer_load_dwordx4 v6, s[12:15], s24 offen offset:2048 sc1 lds
    buffer_load_dwordx4 v6, s[12:15], s24 offen offset:3072 sc1 lds
    s_add_u32 s24, s24, 8192
    s_waitcnt vmcnt(0)
PH_C:
    s_and_b32 s57, s2, 7
    s_lshr_b32 s58, s2, 3
    s_and_b32 s59, s58, 3
    s_lshl_b32 s42, s57, 2
    s_add_u32 s42, s42, s59
    s_lshr_b32 s43, s58, 2
    s_min_u32 s31, s43, 6
    s_lshl_b32 s31, s31, 7
    s_mov_b32 s8, s48
    s_and_b32 s9, s49, 0xffff
    s_mov_b32 s10, 1605632
    s_mov_b32 s11, 0x20000
    s_mov_b32 s16, s40
    s_and_b32 s17, s41, 0xffff
    s_mov_b32 s18, 401408
    s_mov_b32 s19, 0x20000
    v_lshrrev_b32 v5, 5, v1
    v_lshlrev_b32 v5, 2, v5
    v_bfe_u32 v7, v1, 2, 2
    v_add_u32 v5, v5, v7
    v_mul_u32_u24 v5, 896, v5
    v_bfe_u32 v7, v1, 4, 1
    v_lshl_add_u32 v5, v7, 6, v5
    v_and_b32 v7, 3, v1
    v_lshl_add_u32 v5, v7, 4, v5
    s_lshl_b32 s27, s42, 1
    s_add_u32 s27, s27, s26
    s_mul_i32 s28, s27, 112
    s_mul_i32 s57, s22, 28
    s_add_u32 s28, s28, s57
    s_lshl_b32 s28, s28, 10
    s_add_u32 s28, s28, 6291456
    s_lshl_b32 s29, s27, 15
    s_lshl_b32 s57, s22, 13
    s_add_u32 s29, s29, s57
    s_add_u32 s29, s29, 13631488
    s_mul_i32 s30, s22, 28
    s_lshl_b32 s57, s26, 1
    s_add_u32 s30, s30, s57
    s_mul_i32 s30, s30, 14336
    s_add_u32 s30, s30, s31
    s_lshl_b32 s32, s22, 2
    s_add_u32 s32, s32, s26
    s_mul_i32 s32, s32, 25088
    s_add_u32 s32, s32, s31
    s_lshl_b32 s33, s22, 13
    s_lshl_b32 s57, s26, 12
    s_add_u32 s33, s33, s57
    s_lshr_b32 s57, s42, 1
    s_lshl_b32 s57, s57, 8
    v_and_b32 v8, 15, v1
    v_lshlrev_b32 v8, 2, v8
    s_lshl_b32 s58, s27, 8
    v_add_u32 v9, s58, v8
    v_add_u32 v9, 17317888, v9
    v_add_u32 v8, s57, v8
    v_add_u32 v8, 17313792, v8
    s_mov_b32 s80, s50
    s_and_b32 s81, s51, 0xffff
    s_mov_b32 s82, 896
    s_mov_b32 s83, 0x20000
    s_mov_b32 s84, s52
    s_and_b32 s85, s53, 0xffff
    s_mov_b32 s86, 1835008
    s_mov_b32 s87, 0x20000
    v_lshrrev_b32 v12, 5, v1
    v_lshlrev_b32 v12, 9, v12
    v_bfe_u32 v13, v1, 2, 2
    v_lshl_add_u32 v12, v13, 6, v12
    v_bfe_u32 v13, v1, 4, 1
    v_lshl_add_u32 v12, v13, 5, v12
    v_and_b32 v13, 3, v1
    v_lshl_add_u32 v12, v13, 3, v12
    s_lshl_b32 s57, s22, 13
    v_add_u32 v12, s57, v12
    v_add_u32 v13, 0x10000, v12
    v_add_u32 v14, 0x20000, v12
    s_lshr_b32 s34, s22, 1
    s_lshl_b32 s34, s34, 6
    s_add_u32 s34, s34, s31
    s_and_b32 s35, s22, 1
    s_lshl_b32 s35, s35, 5
    s_add_u32 s34, s34, s35
    v_lshrrev_b32 v15, 5, v1
    v_lshlrev_b32 v15, 3, v15
    v_add_u32 v15, s34, v15
    v_and_b32 v11, 31, v1
    s_lshl_b32 s57, s27, 5
    v_add_u32 v11, s57, v11
    v_mul_u32_u24 v11, 896, v11
    v_add_u32 v11, v11, v15
    s_lshl_b32 s24, s21, 6
    s_lshl_b32 s57, s26, 5
    s_add_u32 s24, s24, s57
    s_bfe_u32 s57, s3, 0x10001
    s_add_u32 s24, s24, s57
    s_lshl_b32 s24, s24, 12
    s_and_b32 s57, s3, 1
    s_lshl_b32 s57, s57, 11
    s_add_u32 s24, s24, s57
    s_add_u32 s24, s24, 2097152
    s_lshl_b32 s25, s3, 11
    s_lshl_b32 s57, s26, 13
    v_add_u32 v2, s57, v6
    v_mov_b32 v96, 0
    v_mov_b32 v97, 0
    v_mov_b32 v98, 0
    v_mov_b32 v99, 0
    v_mov_b32 v100, 0
    v_mov_b32 v101, 0
    v_mov_b32 v102, 0
    v_mov_b32 v103, 0
    v_mov_b32 v104, 0
    v_mov_b32 v105, 0
    v_mov_b32 v106, 0
    v_mov_b32 v107, 0
    v_mov_b32 v108, 0
    v_mov_b32 v109, 0
    v_mov_b32 v110, 0
    v_mov_b32 v111, 0
    v_mov_b32 v48, 0
    v_mov_b32 v40, 0
    v_mov_b32 v49, 0
    v_mov_b32 v41, 0
    v_mov_b32 v50, 0
    v_mov_b32 v42, 0
    v_mov_b32 v51, 0
    v_mov_b32 v43, 0
    v_mov_b32 v52, 0
    v_mov_b32 v44, 0
    v_mov_b32 v53, 0
    v_mov_b32 v45, 0
    v_mov_b32 v54, 0
    v_mov_b32 v46, 0
    v_mov_b32 v55, 0
    v_mov_b32 v47, 0
    s_lshl_b32 s57, s22, 11
    s_add_u32 s57, s57, 147456
    v_add_u32 v7, s57, v6
    s_barrier
    s_add_u32 m0, s25, 32768
    s_add_u32 s57, s24, 16384
    buffer_load_dwordx4 v6, s[12:15], s57 offen sc1 lds
    s_add_u32 m0, s25, 33792
    s_add_u32 s57, s24, 17408
    buffer_load_dwordx4 v6, s[12:15], s57 offen sc1 lds
    s_add_u32 m0, s25, 49152
    s_add_u32 s57, s24, 24576
    buffer_load_dwordx4 v6, s[12:15], s57 offen sc1 lds
    s_add_u32 m0, s25, 50176
    s_add_u32 s57, s24, 25600
    buffer_load_dwordx4 v6, s[12:15], s57 offen sc1 lds
    s_cmp_eq_u32 s3, 4
    s_cbranch_scc0 NFH_24
    s_lshl_b32 s60, s20, 8
    s_lshl_b32 s57, s21, 2
    s_add_u32 s60, s60, s57
    s_add_u32 s60, s60, 17313792
    v_mov_b32 v56, s56
    v_mov_b32 v57, 0
    s_mov_b64 s[58:59], exec
    s_mov_b64 exec, 1
    buffer_store_dword v56, v57, s[12:15], s60 offen sc0 sc1
    s_mov_b64 exec, s[58:59]
NFH_24:
    ds_read_b128 v[112:115], v7
    ds_read_b128 v[116:119], v7 offset:1024
    ds_read_b128 v[24:27], v6
    ds_read_b128 v[28:31], v6 offset:1024
    ds_read_b128 v[16:19], v2
    ds_read_b128 v[20:23], v2 offset:1024
    s_waitcnt lgkmcnt(2)
    v_mfma_f32_32x32x16_bf16 v[80:95], v[24:27], v[112:115], 0
    v_mfma_f32_32x32x16_bf16 v[80:95], v[28:31], v[116:119], v[80:95]
    s_nop 11
    v_max3_f32 v56, v80, v81, v82
    v_max3_f32 v56, v56, v83, v84
    v_max3_f32 v56, v56, v85, v86
    v_max3_f32 v56, v56, v87, v88
    v_max3_f32 v56, v56, v89, v90
    v_max3_f32 v56, v56, v91, v92
    v_max3_f32 v56, v56, v93, v94
    v_max_f32 v56, v56, v95
    v_mov_b32 v57, v56
    v_mov_b32 v58, v56
    s_nop 1
    v_permlane32_swap_b32 v57, v58
    v_max_f32 v56, v57, v58
    v_cvt_pk_bf16_f32 v57, v56, v56
    v_and_b32 v57, 0xffff0000, v57
    v_sub_f32 v58, v56, v57
    v_cvt_pk_bf16_f32 v59, v58, v58
    v_and_b32 v59, 0xffff0000, v59
    v_sub_f32 v58, v58, v59
    v_cvt_pk_bf16_f32 v60, -v57, -v59
    v_mov_b32 v61, 0
    v_cvt_pk_bf16_f32 v61, -v58, v61
    v_cmp_le_u32 vcc, 32, v1
    s_nop 1
    v_cndmask_b32 v118, v118, v60, vcc
    v_cndmask_b32 v119, v119, v61, vcc
    s_waitcnt lgkmcnt(0)
    v_mfma_f32_32x32x16_bf16 v[64:79], v[16:19], v[112:115], 0
    v_mfma_f32_32x32x16_bf16 v[64:79], v[20:23], v[116:119], v[64:79]
    ds_read_b128 v[24:27], v2 offset:4096
    ds_read_b128 v[28:31], v2 offset:5120
    ds_read_b128 v[32:35], v2 offset:2048
    ds_read_b128 v[36:39], v2 offset:3072
    s_nop 7
    v_exp_f32 v64, v64
    v_exp_f32 v65, v65
    v_mfma_f32_32x32x16_bf16 v[96:111], v[44:47], v[52:55], v[96:111]
    ds_read_b128 v[16:19], v2 offset:16384
    ds_read_b128 v[20:23], v2 offset:17408
    v_exp_f32 v66, v66
    v_cvt_pk_bf16_f32 v48, v64, v65
    v_exp_f32 v67, v67
    s_and_b32 s57, s42, 3
    s_mul_i32 s57, s57, 448
    s_mul_i32 s58, s3, 56
    s_add_u32 s57, s57, s58
    v_min_u32 v62, 55, v1
    v_add_u32 v62, s57, v62
    v_mul_u32_u24 v62, 896, v62
    buffer_load_dword v63, v62, s[8:11], s31 offen
    v_exp_f32 v68, v68
    v_cvt_pk_bf16_f32 v49, v66, v67
    s_waitcnt lgkmcnt(4)
    v_mfma_f32_32x32x16_bf16 v[80:95], v[24:27], v[112:115], 0
    ds_read_b128 v[40:43], v2 offset:6144
    ds_read_b128 v[44:47], v2 offset:7168
    v_exp_f32 v69, v69
    v_exp_f32 v70, v70
    v_cvt_pk_bf16_f32 v50, v68, v69
    v_exp_f32 v71, v71
    v_exp_f32 v72, v72
    v_cvt_pk_bf16_f32 v51, v70, v71
    v_mfma_f32_32x32x16_bf16 v[80:95], v[28:31], v[116:119], v[80:95]
    v_exp_f32 v73, v73
    v_exp_f32 v74, v74
    v_cvt_pk_bf16_f32 v52, v72, v73
    v_exp_f32 v75, v75
    s_waitcnt lgkmcnt(4)
    v_mfma_f32_32x32x16_bf16 v[96:111], v[32:35], v[48:51], v[96:111]
    v_exp_f32 v76, v76
    v_cvt_pk_bf16_f32 v53, v74, v75
    v_exp_f32 v77, v77
    v_exp_f32 v78, v78
    v_cvt_pk_bf16_f32 v54, v76, v77
    v_exp_f32 v79, v79
    s_nop 0
    v_cvt_pk_bf16_f32 v55, v78, v79
    v_exp_f32 v80, v80
    v_exp_f32 v81, v81
    v_mfma_f32_32x32x16_bf16 v[96:111], v[36:39], v[52:55], v[96:111]
    ds_read_b128 v[24:27], v2 offset:20480
    ds_read_b128 v[28:31], v2 offset:21504
    v_exp_f32 v82, v82
    v_cvt_pk_bf16_f32 v48, v80, v81
    v_exp_f32 v83, v83
    v_exp_f32 v84, v84
    v_cvt_pk_bf16_f32 v49, v82, v83
    s_waitcnt lgkmcnt(4)
    v_mfma_f32_32x32x16_bf16 v[64:79], v[16:19], v[112:115], 0
    ds_read_b128 v[32:35], v2 offset:18432
    ds_read_b128 v[36:39], v2 offset:19456
    v_exp_f32 v85, v85
    v_exp_f32 v86, v86
    v_cvt_pk_bf16_f32 v50, v84, v85
    v_exp_f32 v87, v87
    v_exp_f32 v88, v88
    v_cvt_pk_bf16_f32 v51, v86, v87
    v_mfma_f32_32x32x16_bf16 v[64:79], v[20:23], v[116:119], v[64:79]
    v_exp_f32 v89, v89
    v_exp_f32 v90, v90
    v_cvt_pk_bf16_f32 v52, v88, v89
    v_exp_f32 v91, v91
    s_waitcnt lgkmcnt(4)
    v_mfma_f32_32x32x16_bf16 v[96:111], v[40:43], v[48:51], v[96:111]
    v_exp_f32 v92, v92
    v_cvt_pk_bf16_f32 v53, v90, v91
    v_exp_f32 v93, v93
    v_exp_f32 v94, v94
    v_cvt_pk_bf16_f32 v54, v92, v93
    v_exp_f32 v95, v95
    s_nop 0
    v_cvt_pk_bf16_f32 v55, v94, v95
    s_waitcnt vmcnt(4)
    s_barrier
    v_exp_f32 v64, v64
    v_exp_f32 v65, v65
    v_mfma_f32_32x32x16_bf16 v[96:111], v[44:47], v[52:55], v[96:111]
    ds_read_b128 v[16:19], v2 offset:32768
    ds_read_b128 v[20:23], v2 offset:33792
    v_exp_f32 v66, v66
    v_cvt_pk_bf16_f32 v48, v64, v65
    v_exp_f32 v67, v67
    s_add_u32 m0, s25, 0
    s_add_u32 s57, s24, 32768
    buffer_load_dwordx4 v6, s[12:15], s57 offen sc1 lds
    v_exp_f32 v68, v68
    v_cvt_pk_bf16_f32 v49, v66, v67
    s_waitcnt lgkmcnt(4)
    v_mfma_f32_32x32x16_bf16 v[80:95], v[24:27], v[112:115], 0
    ds_read_b128 v[40:43], v2 offset:22528
    ds_read_b128 v[44:47], v2 offset:23552
    v_exp_f32 v69, v69
    v_exp_f32 v70, v70
    v_cvt_pk_bf16_f32 v50, v68, v69
    s_add_u32 m0, s25, 1024
    s_add_u32 s57, s24, 33792
    buffer_load_dwordx4 v6, s[12:15], s57 offen sc1 lds
    v_exp_f32 v71, v71
    v_exp_f32 v72, v72
    v_cvt_pk_bf16_f32 v51, v70, v71
    v_mfma_f32_32x32x16_bf16 v[80:95], v[28:31], v[116:119], v[80:95]
    v_exp_f32 v73, v73
    v_exp_f32 v74, v74
    v_cvt_pk_bf16_f32 v52, v72, v73
    v_exp_f32 v75, v75
    s_waitcnt lgkmcnt(4)
    v_mfma_f32_32x32x16_bf16 v[96:111], v[32:35], v[48:51], v[96:111]
    v_exp_f32 v76, v76
    v_cvt_pk_bf16_f32 v53, v74, v75
    v_exp_f32 v77, v77
    v_exp_f32 v78, v78
    v_cvt_pk_bf16_f32 v54, v76, v77
    v_exp_f32 v79, v79
    s_nop 0
    v_cvt_pk_bf16_f32 v55, v78, v79
    v_exp_f32 v80, v80
    v_exp_f32 v81, v81
    v_mfma_f32_32x32x16_bf16 v[96:111], v[36:39], v[52:55], v[96:111]
    ds_read_b128 v[24:27], v2 offset:36864
    ds_read_b128 v[28:31], v2 offset:37888
    v_exp_f32 v82, v82
    v_cvt_pk_bf16_f32 v48, v80, v81
    v_exp_f32 v83, v83
    s_and_b32 s57, s42, 3
    s_mul_i32 s57, s57, 112
    s_mul_i32 s58, s3, 14
    s_add_u32 s57, s57, s58
    v_min_u32 v62, 13, v1
    v_add_u32 v62, s57, v62
    v_mul_u32_u24 v62, 896, v62
    buffer_load_dword v63, v62, s[16:19], s31 offen
    v_exp_f32 v84, v84
    v_cvt_pk_bf16_f32 v49, v82, v83
    s_waitcnt lgkmcnt(4)
    v_mfma_f32_32x32x16_bf16 v[64:79], v[16:19], v[112:115], 0
    ds_read_b128 v[32:35], v2 offset:34816
    ds_read_b128 v[36:39], v2 offset:35840
    v_exp_f32 v85, v85
    v_exp_f32 v86, v86
    v_cvt_pk_bf16_f32 v50, v84, v85
    v_exp_f32 v87, v87
    v_exp_f32 v88, v88
    v_cvt_pk_bf16_f32 v51, v86, v87
    v_mfma_f32_32x32x16_bf16 v[64:79], v[20:23], v[116:119], v[64:79]
    v_exp_f32 v89, v89
    v_exp_f32 v90, v90
    v_cvt_pk_bf16_f32 v52, v88, v89
    v_exp_f32 v91, v91
    s_waitcnt lgkmcnt(4)
    v_mfma_f32_32x32x16_bf16 v[96:111], v[40:43], v[48:51], v[96:111]
    v_exp_f32 v92, v92
    v_cvt_pk_bf16_f32 v53, v90, v91
    v_exp_f32 v93, v93
    v_exp_f32 v94, v94
    v_cvt_pk_bf16_f32 v54, v92, v93
    v_exp_f32 v95, v95
    s_nop 0
    v_cvt_pk_bf16_f32 v55, v94, v95
    s_waitcnt vmcnt(5)
    s_barrier
    v_exp_f32 v64, v64
    v_exp_f32 v65, v65
    v_mfma_f32_32x32x16_bf16 v[96:111], v[44:47], v[52:55], v[96:111]
    ds_read_b128 v[16:19], v2 offset:49152
    ds_read_b128 v[20:23], v2 offset:50176
    v_exp_f32 v66, v66
    v_cvt_pk_bf16_f32 v48, v64, v65
    v_exp_f32 v67, v67
    s_add_u32 m0, s25, 16384
    s_add_u32 s57, s24, 40960
    buffer_load_dwordx4 v6, s[12:15], s57 offen sc1 lds
    v_exp_f32 v68, v68
    v_cvt_pk_bf16_f32 v49, v66, v67
    s_waitcnt lgkmcnt(4)
    v_mfma_f32_32x32x16_bf16 v[80:95], v[24:27], v[112:115], 0
    ds_read_b128 v[40:43], v2 offset:38912
    ds_read_b128 v[44:47], v2 offset:39936
    v_exp_f32 v69, v69
    v_exp_f32 v70, v70
    v_cvt_pk_bf16_f32 v50, v68, v69
    s_add_u32 m0, s25, 17408
    s_add_u32 s57, s24, 41984
    buffer_load_dwordx4 v6, s[12:15], s57 offen sc1 lds
    v_exp_f32 v71, v71
    v_exp_f32 v72, v72
    v_cvt_pk_bf16_f32 v51, v70, v71
    v_mfma_f32_32x32x16_bf16 v[80:95], v[28:31], v[116:119], v[80:95]
    v_exp_f32 v73, v73
    v_exp_f32 v74, v74
    v_cvt_pk_bf16_f32 v52, v72, v73
    v_exp_f32 v75, v75
    s_waitcnt lgkmcnt(4)
    v_mfma_f32_32x32x16_bf16 v[96:111], v[32:35], v[48:51], v[96:111]
    v_exp_f32 v76, v76
    v_cvt_pk_bf16_f32 v53, v74, v75
    v_exp_f32 v77, v77
    v_exp_f32 v78, v78
    v_cvt_pk_bf16_f32 v54, v76, v77
    v_exp_f32 v79, v79
    s_nop 0
    v_cvt_pk_bf16_f32 v55, v78, v79
    v_exp_f32 v80, v80
    v_exp_f32 v81, v81
    v_mfma_f32_32x32x16_bf16 v[96:111], v[36:39], v[52:55], v[96:111]
    ds_read_b128 v[24:27], v2 offset:53248
    ds_read_b128 v[28:31], v2 offset:54272
    v_exp_f32 v82, v82
    v_cvt_pk_bf16_f32 v48, v80, v81
    v_exp_f32 v83, v83
    buffer_load_dword v10, v8, s[12:15], 0 offen sc0 sc1
    v_exp_f32 v84, v84
    v_cvt_pk_bf16_f32 v49, v82, v83
    s_waitcnt lgkmcnt(4)
    v_mfma_f32_32x32x16_bf16 v[64:79], v[16:19], v[112:115], 0
    ds_read_b128 v[32:35], v2 offset:51200
    ds_read_b128 v[36:39], v2 offset:52224
    v_exp_f32 v85, v85
    v_exp_f32 v86, v86
    v_cvt_pk_bf16_f32 v50, v84, v85
    v_exp_f32 v87, v87
    v_exp_f32 v88, v88
    v_cvt_pk_bf16_f32 v51, v86, v87
    v_mfma_f32_32x32x16_bf16 v[64:79], v[20:23], v[116:119], v[64:79]
    v_exp_f32 v89, v89
    v_exp_f32 v90, v90
    v_cvt_pk_bf16_f32 v52, v88, v89
    v_exp_f32 v91, v91
    s_waitcnt lgkmcnt(4)
    v_mfma_f32_32x32x16_bf16 v[96:111], v[40:43], v[48:51], v[96:111]
    v_exp_f32 v92, v92
    v_cvt_pk_bf16_f32 v53, v90, v91
    v_exp_f32 v93, v93
    v_exp_f32 v94, v94
    v_cvt_pk_bf16_f32 v54, v92, v93
    v_exp_f32 v95, v95
    s_nop 0
    v_cvt_pk_bf16_f32 v55, v94, v95
    s_waitcnt vmcnt(4)
    s_barrier
    v_exp_f32 v64, v64
    v_exp_f32 v65, v65
    v_mfma_f32_32x32x16_bf16 v[96:111], v[44:47], v[52:55], v[96:111]
    ds_read_b128 v[16:19], v2 offset:0
    ds_read_b128 v[20:23], v2 offset:1024
    v_exp_f32 v66, v66
    v_cvt_pk_bf16_f32 v48, v64, v65
    v_exp_f32 v67, v67
    s_add_u32 m0, s25, 32768
    s_add_u32 s57, s24, 49152
    buffer_load_dwordx4 v6, s[12:15], s57 offen sc1 lds
    v_exp_f32 v68, v68
    v_cvt_pk_bf16_f32 v49, v66, v67
    s_waitcnt lgkmcnt(4)
    v_mfma_f32_32x32x16_bf16 v[80:95], v[24:27], v[112:115], 0
    ds_read_b128 v[40:43], v2 offset:55296
    ds_read_b128 v[44:47], v2 offset:56320
    v_exp_f32 v69, v69
    v_exp_f32 v70, v70
    v_cvt_pk_bf16_f32 v50, v68, v69
    s_add_u32 m0, s25, 33792
    s_add_u32 s57, s24, 50176
    buffer_load_dwordx4 v6, s[12:15], s57 offen sc1 lds
    v_exp_f32 v71, v71
    v_exp_f32 v72, v72
    v_cvt_pk_bf16_f32 v51, v70, v71
    v_mfma_f32_32x32x16_bf16 v[80:95], v[28:31], v[116:119], v[80:95]
    v_exp_f32 v73, v73
    v_exp_f32 v74, v74
    v_cvt_pk_bf16_f32 v52, v72, v73
    s_add_u32 m0, s33, 65536
    s_add_u32 s57, s30, 0
    buffer_load_dwordx4 v5, s[8:11], s57 offen lds
    v_exp_f32 v75, v75
    s_waitcnt lgkmcnt(4)
    v_mfma_f32_32x32x16_bf16 v[96:111], v[32:35], v[48:51], v[96:111]
    v_exp_f32 v76, v76
    v_cvt_pk_bf16_f32 v53, v74, v75
    v_exp_f32 v77, v77
    v_exp_f32 v78, v78
    v_cvt_pk_bf16_f32 v54, v76, v77
    v_exp_f32 v79, v79
    s_nop 0
    v_cvt_pk_bf16_f32 v55, v78, v79
    v_exp_f32 v80, v80
    v_exp_f32 v81, v81
    v_mfma_f32_32x32x16_bf16 v[96:111], v[36:39], v[52:55], v[96:111]
    ds_read_b128 v[24:27], v2 offset:4096
    ds_read_b128 v[28:31], v2 offset:5120
    v_exp_f32 v82, v82
    v_cvt_pk_bf16_f32 v48, v80, v81
    v_exp_f32 v83, v83
    s_add_u32 m0, s33, 66560
    s_add_u32 s57, s30, 7168
    buffer_load_dwordx4 v5, s[8:11], s57 offen lds
    v_exp_f32 v84, v84
    v_cvt_pk_bf16_f32 v49, v82, v83
    s_waitcnt lgkmcnt(4)
    v_mfma_f32_32x32x16_bf16 v[64:79], v[16:19], v[112:115], 0
    ds_read_b128 v[32:35], v2 offset:2048
    ds_read_b128 v[36:39], v2 offset:3072
    v_exp_f32 v85, v85
    v_exp_f32 v86, v86
    v_cvt_pk_bf16_f32 v50, v84, v85
    s_add_u32 m0, s33, 67584
    s_add_u32 s57, s30, 14336
    buffer_load_dwordx4 v5, s[8:11], s57 offen lds
    v_exp_f32 v87, v87
    v_exp_f32 v88, v88
    v_cvt_pk_bf16_f32 v51, v86, v87
    v_mfma_f32_32x32x16_bf16 v[64:79], v[20:23], v[116:119], v[64:79]
    v_exp_f32 v89, v89
    v_exp_f32 v90, v90
    v_cvt_pk_bf16_f32 v52, v88, v89
    s_add_u32 m0, s33, 68608
    s_add_u32 s57, s30, 21504
    buffer_load_dwordx4 v5, s[8:11], s57 offen lds
    v_exp_f32 v91, v91
    s_waitcnt lgkmcnt(4)
    v_mfma_f32_32x32x16_bf16 v[96:111], v[40:43], v[48:51], v[96:111]
    v_exp_f32 v92, v92
    v_cvt_pk_bf16_f32 v53, v90, v91
    v_exp_f32 v93, v93
    v_exp_f32 v94, v94
    v_cvt_pk_bf16_f32 v54, v92, v93
    v_exp_f32 v95, v95
    s_nop 0
    v_cvt_pk_bf16_f32 v55, v94, v95
    s_waitcnt vmcnt(7)
    s_barrier
    v_exp_f32 v64, v64
    v_exp_f32 v65, v65
    v_mfma_f32_32x32x16_bf16 v[96:111], v[44:47], v[52:55], v[96:111]
    ds_read_b128 v[16:19], v2 offset:16384
    ds_read_b128 v[20:23], v2 offset:17408
    v_exp_f32 v66, v66
    v_cvt_pk_bf16_f32 v48, v64, v65
    v_exp_f32 v67, v67
    s_add_u32 m0, s25, 49152
    s_add_u32 s57, s24, 57344
    buffer_load_dwordx4 v6, s[12:15], s57 offen sc1 lds
    v_exp_f32 v68, v68
    v_cvt_pk_bf16_f32 v49, v66, v67
    s_waitcnt lgkmcnt(4)
    v_mfma_f32_32x32x16_bf16 v[80:95], v[24:27], v[112:115], 0
    ds_read_b128 v[40:43], v2 offset:6144
    ds_read_b128 v[44:47], v2 offset:7168
    v_exp_f32 v69, v69
    v_exp_f32 v70, v70
    v_cvt_pk_bf16_f32 v50, v68, v69
    s_add_u32 m0, s25, 50176
    s_add_u32 s57, s24, 58368
    buffer_load_dwordx4 v6, s[12:15], s57 offen sc1 lds
    v_exp_f32 v71, v71
    v_exp_f32 v72, v72
    v_cvt_pk_bf16_f32 v51, v70, v71
    v_mfma_f32_32x32x16_bf16 v[80:95], v[28:31], v[116:119], v[80:95]
    v_exp_f32 v73, v73
    v_exp_f32 v74, v74
    v_cvt_pk_bf16_f32 v52, v72, v73
    s_add_u32 m0, s33, 98304
    s_add_u32 s57, s30, 57344
    buffer_load_dwordx4 v5, s[8:11], s57 offen lds
    v_exp_f32 v75, v75
    s_waitcnt lgkmcnt(4)
    v_mfma_f32_32x32x16_bf16 v[96:111], v[32:35], v[48:51], v[96:111]
    v_exp_f32 v76, v76
    v_cvt_pk_bf16_f32 v53, v74, v75
    v_exp_f32 v77, v77
    v_exp_f32 v78, v78
    v_cvt_pk_bf16_f32 v54, v76, v77
    v_exp_f32 v79, v79
    s_nop 0
    v_cvt_pk_bf16_f32 v55, v78, v79
    v_exp_f32 v80, v80
    v_exp_f32 v81, v81
    v_mfma_f32_32x32x16_bf16 v[96:111], v[36:39], v[52:55], v[96:111]
    ds_read_b128 v[24:27], v2 offset:20480
    ds_read_b128 v[28:31], v2 offset:21504
    v_exp_f32 v82, v82
    v_cvt_pk_bf16_f32 v48, v80, v81
    v_exp_f32 v83, v83
    s_add_u32 m0, s33, 99328
    s_add_u32 s57, s30, 64512
    buffer_load_dwordx4 v5, s[8:11], s57 offen lds
    v_exp_f32 v84, v84
    v_cvt_pk_bf16_f32 v49, v82, v83
    s_waitcnt lgkmcnt(4)
    v_mfma_f32_32x32x16_bf16 v[64:79], v[16:19], v[112:115], 0
    ds_read_b128 v[32:35], v2 offset:18432
    ds_read_b128 v[36:39], v2 offset:19456
    v_exp_f32 v85, v85
    v_exp_f32 v86, v86
    v_cvt_pk_bf16_f32 v50, v84, v85
    s_add_u32 m0, s33, 100352
    s_add_u32 s57, s30, 71680
    buffer_load_dwordx4 v5, s[8:11], s57 offen lds
    v_exp_f32 v87, v87
    v_exp_f32 v88, v88
    v_cvt_pk_bf16_f32 v51, v86, v87
    v_mfma_f32_32x32x16_bf16 v[64:79], v[20:23], v[116:119], v[64:79]
    v_exp_f32 v89, v89
    v_exp_f32 v90, v90
    v_cvt_pk_bf16_f32 v52, v88, v89
    s_add_u32 m0, s33, 101376
    s_add_u32 s57, s30, 78848
    buffer_load_dwordx4 v5, s[8:11], s57 offen lds
    v_exp_f32 v91, v91
    s_waitcnt lgkmcnt(4)
    v_mfma_f32_32x32x16_bf16 v[96:111], v[40:43], v[48:51], v[96:111]
    v_exp_f32 v92, v92
    v_cvt_pk_bf16_f32 v53, v90, v91
    v_exp_f32 v93, v93
    v_exp_f32 v94, v94
    v_cvt_pk_bf16_f32 v54, v92, v93
    v_exp_f32 v95, v95
    s_nop 0
    v_cvt_pk_bf16_f32 v55, v94, v95
    s_waitcnt vmcnt(10)
    s_barrier
    s_waitcnt vmcnt(12)
    s_mov_b32 s57, 0
    s_branch POLLC_27
POLL_25:
    buffer_load_dword v10, v8, s[12:15], 0 offen sc0 sc1
    s_waitcnt vmcnt(0)
POLLC_27:
    v_cmp_ne_u32 vcc, s56, v10
    s_nop 1
    s_cmp_eq_u64 vcc, 0
    s_cbranch_scc1 POLLD_26
    s_add_u32 s57, s57, 1
    s_cmp_gt_u32 s57, 0x40000
    s_cbranch_scc1 POLLD_26
    s_sleep 1
    s_branch POLL_25
POLLD_26:
    v_exp_f32 v64, v64
    v_exp_f32 v65, v65
    v_mfma_f32_32x32x16_bf16 v[96:111], v[44:47], v[52:55], v[96:111]
    ds_read_b128 v[16:19], v2 offset:32768
    ds_read_b128 v[20:23], v2 offset:33792
    v_exp_f32 v66, v66
    v_cvt_pk_bf16_f32 v48, v64, v65
    v_exp_f32 v67, v67
    s_add_u32 m0, s25, 0
    s_add_u32 s57, s24, 65536
    buffer_load_dwordx4 v6, s[12:15], s57 offen sc1 lds
    v_exp_f32 v68, v68
    v_cvt_pk_bf16_f32 v49, v66, v67
    s_waitcnt lgkmcnt(4)
    v_mfma_f32_32x32x16_bf16 v[80:95], v[24:27], v[112:115], 0
    ds_read_b128 v[40:43], v2 offset:22528
    ds_read_b128 v[44:47], v2 offset:23552
    v_exp_f32 v69, v69
    v_exp_f32 v70, v70
    v_cvt_pk_bf16_f32 v50, v68, v69
    s_add_u32 m0, s25, 1024
    s_add_u32 s57, s24, 66560
    buffer_load_dwordx4 v6, s[12:15], s57 offen sc1 lds
    v_exp_f32 v71, v71
    v_exp_f32 v72, v72
    v_cvt_pk_bf16_f32 v51, v70, v71
    v_mfma_f32_32x32x16_bf16 v[80:95], v[28:31], v[116:119], v[80:95]
    v_exp_f32 v73, v73
    v_exp_f32 v74, v74
    v_cvt_pk_bf16_f32 v52, v72, v73
    s_add_u32 m0, s33, 131072
    s_add_u32 s57, s30, 114688
    buffer_load_dwordx4 v5, s[8:11], s57 offen lds
    v_exp_f32 v75, v75
    s_waitcnt lgkmcnt(4)
    v_mfma_f32_32x32x16_bf16 v[96:111], v[32:35], v[48:51], v[96:111]
    v_exp_f32 v76, v76
    v_cvt_pk_bf16_f32 v53, v74, v75
    v_exp_f32 v77, v77
    v_exp_f32 v78, v78
    v_cvt_pk_bf16_f32 v54, v76, v77
    v_exp_f32 v79, v79
    s_nop 0
    v_cvt_pk_bf16_f32 v55, v78, v79
    v_exp_f32 v80, v80
    v_exp_f32 v81, v81
    v_mfma_f32_32x32x16_bf16 v[96:111], v[36:39], v[52:55], v[96:111]
    ds_read_b128 v[24:27], v2 offset:36864
    ds_read_b128 v[28:31], v2 offset:37888
    v_exp_f32 v82, v82
    v_cvt_pk_bf16_f32 v48, v80, v81
    v_exp_f32 v83, v83
    s_add_u32 m0, s33, 132096
    s_add_u32 s57, s30, 121856
    buffer_load_dwordx4 v5, s[8:11], s57 offen lds
    v_exp_f32 v84, v84
    v_cvt_pk_bf16_f32 v49, v82, v83
    s_waitcnt lgkmcnt(4)
    v_mfma_f32_32x32x16_bf16 v[64:79], v[16:19], v[112:115], 0
    ds_read_b128 v[32:35], v2 offset:34816
    ds_read_b128 v[36:39], v2 offset:35840
    v_exp_f32 v85, v85
    v_exp_f32 v86, v86
    v_cvt_pk_bf16_f32 v50, v84, v85
    s_add_u32 m0, s33, 133120
    s_add_u32 s57, s30, 129024
    buffer_load_dwordx4 v5, s[8:11], s57 offen lds
    v_exp_f32 v87, v87
    v_exp_f32 v88, v88
    v_cvt_pk_bf16_f32 v51, v86, v87
    v_mfma_f32_32x32x16_bf16 v[64:79], v[20:23], v[116:119], v[64:79]
    v_exp_f32 v89, v89
    v_exp_f32 v90, v90
    v_cvt_pk_bf16_f32 v52, v88, v89
    s_add_u32 m0, s33, 134144
    s_add_u32 s57, s30, 136192
    buffer_load_dwordx4 v5, s[8:11], s57 offen lds
    v_exp_f32 v91, v91
    s_waitcnt lgkmcnt(4)
    v_mfma_f32_32x32x16_bf16 v[96:111], v[40:43], v[48:51], v[96:111]
    v_exp_f32 v92, v92
    v_cvt_pk_bf16_f32 v53, v90, v91
    v_exp_f32 v93, v93
    v_exp_f32 v94, v94
    v_cvt_pk_bf16_f32 v54, v92, v93
    v_exp_f32 v95, v95
    s_nop 0
    v_cvt_pk_bf16_f32 v55, v94, v95
    s_waitcnt vmcnt(10)
    s_barrier
    v_exp_f32 v64, v64
    v_exp_f32 v65, v65
    v_mfma_f32_32x32x16_bf16 v[96:111], v[44:47], v[52:55], v[96:111]
    ds_read_b128 v[16:19], v2 offset:49152
    ds_read_b128 v[20:23], v2 offset:50176
    v_exp_f32 v66, v66
    v_cvt_pk_bf16_f32 v48, v64, v65
    v_exp_f32 v67, v67
    s_add_u32 m0, s25, 16384
    s_add_u32 s57, s24, 73728
    buffer_load_dwordx4 v6, s[12:15], s57 offen sc1 lds
    v_exp_f32 v68, v68
    v_cvt_pk_bf16_f32 v49, v66, v67
    s_waitcnt lgkmcnt(4)
    v_mfma_f32_32x32x16_bf16 v[80:95], v[24:27], v[112:115], 0
    ds_read_b128 v[40:43], v2 offset:38912
    ds_read_b128 v[44:47], v2 offset:39936
    v_exp_f32 v69, v69
    v_exp_f32 v70, v70
    v_cvt_pk_bf16_f32 v50, v68, v69
    s_add_u32 m0, s25, 17408
    s_add_u32 s57, s24, 74752
    buffer_load_dwordx4 v6, s[12:15], s57 offen sc1 lds
    v_exp_f32 v71, v71
    v_exp_f32 v72, v72
    v_cvt_pk_bf16_f32 v51, v70, v71
    v_mfma_f32_32x32x16_bf16 v[80:95], v[28:31], v[116:119], v[80:95]
    v_exp_f32 v73, v73
    v_exp_f32 v74, v74
    v_cvt_pk_bf16_f32 v52, v72, v73
    s_add_u32 s57, s28, 0
    buffer_load_dwordx4 v[128:131], v6, s[12:15], s57 offen sc1
    v_exp_f32 v75, v75
    s_waitcnt lgkmcnt(4)
    v_mfma_f32_32x32x16_bf16 v[96:111], v[32:35], v[48:51], v[96:111]
    v_exp_f32 v76, v76
    v_cvt_pk_bf16_f32 v53, v74, v75
    v_exp_f32 v77, v77
    v_exp_f32 v78, v78
    v_cvt_pk_bf16_f32 v54, v76, v77
    v_exp_f32 v79, v79
    s_nop 0
    v_cvt_pk_bf16_f32 v55, v78, v79
    v_exp_f32 v80, v80
    v_exp_f32 v81, v81
    v_mfma_f32_32x32x16_bf16 v[96:111], v[36:39], v[52:55], v[96:111]
    ds_read_b128 v[24:27], v2 offset:53248
    ds_read_b128 v[28:31], v2 offset:54272
    v_exp_f32 v82, v82
    v_cvt_pk_bf16_f32 v48, v80, v81
    v_exp_f32 v83, v83
    s_add_u32 s57, s28, 1024
    buffer_load_dwordx4 v[132:135], v6, s[12:15], s57 offen sc1
    v_exp_f32 v84, v84
    v_cvt_pk_bf16_f32 v49, v82, v83
    s_waitcnt lgkmcnt(4)
    v_mfma_f32_32x32x16_bf16 v[64:79], v[16:19], v[112:115], 0
    ds_read_b128 v[32:35], v2 offset:51200
    ds_read_b128 v[36:39], v2 offset:52224
    v_exp_f32 v85, v85
    v_exp_f32 v86, v86
    v_cvt_pk_bf16_f32 v50, v84, v85
    s_add_u32 s57, s28, 2048
    buffer_load_dwordx4 v[136:139], v6, s[12:15], s57 offen sc1
    v_exp_f32 v87, v87
    v_exp_f32 v88, v88
    v_cvt_pk_bf16_f32 v51, v86, v87
    v_mfma_f32_32x32x16_bf16 v[64:79], v[20:23], v[116:119], v[64:79]
    v_exp_f32 v89, v89
    v_exp_f32 v90, v90
    v_cvt_pk_bf16_f32 v52, v88, v89
    s_add_u32 s57, s28, 3072
    buffer_load_dwordx4 v[140:143], v6, s[12:15], s57 offen sc1
    v_exp_f32 v91, v91
    s_waitcnt lgkmcnt(4)
    v_mfma_f32_32x32x16_bf16 v[96:111], v[40:43], v[48:51], v[96:111]
    v_exp_f32 v92, v92
    v_cvt_pk_bf16_f32 v53, v90, v91
    v_exp_f32 v93, v93
    v_exp_f32 v94, v94
    v_cvt_pk_bf16_f32 v54, v92, v93
    v_exp_f32 v95, v95
    s_nop 0
    v_cvt_pk_bf16_f32 v55, v94, v95
    s_waitcnt vmcnt(10)
    s_barrier
    v_exp_f32 v64, v64
    v_exp_f32 v65, v65
    v_mfma_f32_32x32x16_bf16 v[96:111], v[44:47], v[52:55], v[96:111]
    ds_read_b128 v[16:19], v2 offset:0
    ds_read_b128 v[20:23], v2 offset:1024
    v_exp_f32 v66, v66
    v_cvt_pk_bf16_f32 v48, v64, v65
    v_exp_f32 v67, v67
    s_add_u32 m0, s25, 32768
    s_add_u32 s57, s24, 81920
    buffer_load_dwordx4 v6, s[12:15], s57 offen sc1 lds
    v_exp_f32 v68, v68
    v_cvt_pk_bf16_f32 v49, v66, v67
    s_waitcnt lgkmcnt(4)
    v_mfma_f32_32x32x16_bf16 v[80:95], v[24:27], v[112:115], 0
    ds_read_b128 v[40:43], v2 offset:55296
    ds_read_b128 v[44:47], v2 offset:56320
    v_exp_f32 v69, v69
    v_exp_f32 v70, v70
    v_cvt_pk_bf16_f32 v50, v68, v69
    s_add_u32 m0, s25, 33792
    s_add_u32 s57, s24, 82944
    buffer_load_dwordx4 v6, s[12:15], s57 offen sc1 lds
    v_exp_f32 v71, v71
    v_exp_f32 v72, v72
    v_cvt_pk_bf16_f32 v51, v70, v71
    v_mfma_f32_32x32x16_bf16 v[80:95], v[28:31], v[116:119], v[80:95]
    v_exp_f32 v73, v73
    v_exp_f32 v74, v74
    v_cvt_pk_bf16_f32 v52, v72, v73
    s_add_u32 s57, s28, 4096
    buffer_load_dwordx4 v[144:147], v6, s[12:15], s57 offen sc1
    v_exp_f32 v75, v75
    s_waitcnt lgkmcnt(4)
    v_mfma_f32_32x32x16_bf16 v[96:111], v[32:35], v[48:51], v[96:111]
    v_exp_f32 v76, v76
    v_cvt_pk_bf16_f32 v53, v74, v75
    v_exp_f32 v77, v77
    v_exp_f32 v78, v78
    v_cvt_pk_bf16_f32 v54, v76, v77
    v_exp_f32 v79, v79
    s_nop 0
    v_cvt_pk_bf16_f32 v55, v78, v79
    v_exp_f32 v80, v80
    v_exp_f32 v81, v81
    v_mfma_f32_32x32x16_bf16 v[96:111], v[36:39], v[52:55], v[96:111]
    ds_read_b128 v[24:27], v2 offset:4096
    ds_read_b128 v[28:31], v2 offset:5120
    v_exp_f32 v82, v82
    v_cvt_pk_bf16_f32 v48, v80, v81
    v_exp_f32 v83, v83
    s_add_u32 s57, s28, 5120
    buffer_load_dwordx4 v[148:151], v6, s[12:15], s57 offen sc1
    v_exp_f32 v84, v84
    v_cvt_pk_bf16_f32 v49, v82, v83
    s_waitcnt lgkmcnt(4)
    v_mfma_f32_32x32x16_bf16 v[64:79], v[16:19], v[112:115], 0
    ds_read_b128 v[32:35], v2 offset:2048
    ds_read_b128 v[36:39], v2 offset:3072
    v_exp_f32 v85, v85
    v_exp_f32 v86, v86
    v_cvt_pk_bf16_f32 v50, v84, v85
    s_add_u32 s57, s28, 6144
    buffer_load_dwordx4 v[152:155], v6, s[12:15], s57 offen sc1
    v_exp_f32 v87, v87
    v_exp_f32 v88, v88
    v_cvt_pk_bf16_f32 v51, v86, v87
    v_mfma_f32_32x32x16_bf16 v[64:79], v[20:23], v[116:119], v[64:79]
    v_exp_f32 v89, v89
    v_exp_f32 v90, v90
    v_cvt_pk_bf16_f32 v52, v88, v89
    s_add_u32 s57, s28, 7168
    buffer_load_dwordx4 v[156:159], v6, s[12:15], s57 offen sc1
    v_exp_f32 v91, v91
    s_waitcnt lgkmcnt(4)
    v_mfma_f32_32x32x16_bf16 v[96:111], v[40:43], v[48:51], v[96:111]
    v_exp_f32 v92, v92
    v_cvt_pk_bf16_f32 v53, v90, v91
    v_exp_f32 v93, v93
    v_exp_f32 v94, v94
    v_cvt_pk_bf16_f32 v54, v92, v93
    v_exp_f32 v95, v95
    s_nop 0
    v_cvt_pk_bf16_f32 v55, v94, v95
    s_waitcnt vmcnt(10)
    s_barrier
    v_exp_f32 v64, v64
    v_exp_f32 v65, v65
    v_mfma_f32_32x32x16_bf16 v[96:111], v[44:47], v[52:55], v[96:111]
    ds_read_b128 v[16:19], v2 offset:16384
    ds_read_b128 v[20:23], v2 offset:17408
    v_exp_f32 v66, v66
    v_cvt_pk_bf16_f32 v48, v64, v65
    v_exp_f32 v67, v67
    s_add_u32 m0, s25, 49152
    s_add_u32 s57, s24, 90112
    buffer_load_dwordx4 v6, s[12:15], s57 offen sc1 lds
    v_exp_f32 v68, v68
    v_cvt_pk_bf16_f32 v49, v66, v67
    s_waitcnt lgkmcnt(4)
    v_mfma_f32_32x32x16_bf16 v[80:95], v[24:27], v[112:115], 0
    ds_read_b128 v[40:43], v2 offset:6144
    ds_read_b128 v[44:47], v2 offset:7168
    v_exp_f32 v69, v69
    v_exp_f32 v70, v70
    v_cvt_pk_bf16_f32 v50, v68, v69
    s_add_u32 m0, s25, 50176
    s_add_u32 s57, s24, 91136
    buffer_load_dwordx4 v6, s[12:15], s57 offen sc1 lds
    v_exp_f32 v71, v71
    v_exp_f32 v72, v72
    v_cvt_pk_bf16_f32 v51, v70, v71
    v_mfma_f32_32x32x16_bf16 v[80:95], v[28:31], v[116:119], v[80:95]
    v_exp_f32 v73, v73
    v_exp_f32 v74, v74
    v_cvt_pk_bf16_f32 v52, v72, v73
    s_add_u32 s57, s28, 8192
    buffer_load_dwordx4 v[160:163], v6, s[12:15], s57 offen sc1
    v_exp_f32 v75, v75
    s_waitcnt lgkmcnt(4)
    v_mfma_f32_32x32x16_bf16 v[96:111], v[32:35], v[48:51], v[96:111]
    v_exp_f32 v76, v76
    v_cvt_pk_bf16_f32 v53, v74, v75
    v_exp_f32 v77, v77
    v_exp_f32 v78, v78
    v_cvt_pk_bf16_f32 v54, v76, v77
    v_exp_f32 v79, v79
    s_nop 0
    v_cvt_pk_bf16_f32 v55, v78, v79
    v_exp_f32 v80, v80
    v_exp_f32 v81, v81
    v_mfma_f32_32x32x16_bf16 v[96:111], v[36:39], v[52:55], v[96:111]
    ds_read_b128 v[24:27], v2 offset:20480
    ds_read_b128 v[28:31], v2 offset:21504
    v_exp_f32 v82, v82
    v_cvt_pk_bf16_f32 v48, v80, v81
    v_exp_f32 v83, v83
    s_add_u32 s57, s28, 9216
    buffer_load_dwordx4 v[164:167], v6, s[12:15], s57 offen sc1
    v_exp_f32 v84, v84
    v_cvt_pk_bf16_f32 v49, v82, v83
    s_waitcnt lgkmcnt(4)
    v_mfma_f32_32x32x16_bf16 v[64:79], v[16:19], v[112:115], 0
    ds_read_b128 v[32:35], v2 offset:18432
    ds_read_b128 v[36:39], v2 offset:19456
    v_exp_f32 v85, v85
    v_exp_f32 v86, v86
    v_cvt_pk_bf16_f32 v50, v84, v85
    s_add_u32 s57, s28, 10240
    buffer_load_dwordx4 v[168:171], v6, s[12:15], s57 offen sc1
    v_exp_f32 v87, v87
    v_exp_f32 v88, v88
    v_cvt_pk_bf16_f32 v51, v86, v87
    v_mfma_f32_32x32x16_bf16 v[64:79], v[20:23], v[116:119], v[64:79]
    v_exp_f32 v89, v89
    v_exp_f32 v90, v90
    v_cvt_pk_bf16_f32 v52, v88, v89
    s_add_u32 s57, s28, 11264
    buffer_load_dwordx4 v[172:175], v6, s[12:15], s57 offen sc1
    v_exp_f32 v91, v91
    s_waitcnt lgkmcnt(4)
    v_mfma_f32_32x32x16_bf16 v[96:111], v[40:43], v[48:51], v[96:111]
    v_exp_f32 v92, v92
    v_cvt_pk_bf16_f32 v53, v90, v91
    v_exp_f32 v93, v93
    v_exp_f32 v94, v94
    v_cvt_pk_bf16_f32 v54, v92, v93
    v_exp_f32 v95, v95
    s_nop 0
    v_cvt_pk_bf16_f32 v55, v94, v95
    s_waitcnt vmcnt(10)
    s_barrier
    v_exp_f32 v64, v64
    v_exp_f32 v65, v65
    v_mfma_f32_32x32x16_bf16 v[96:111], v[44:47], v[52:55], v[96:111]
    ds_read_b128 v[16:19], v2 offset:32768
    ds_read_b128 v[20:23], v2 offset:33792
    v_exp_f32 v66, v66
    v_cvt_pk_bf16_f32 v48, v64, v65
    v_exp_f32 v67, v67
    s_add_u32 m0, s25, 0
    s_add_u32 s57, s24, 98304
    buffer_load_dwordx4 v6, s[12:15], s57 offen sc1 lds
    v_exp_f32 v68, v68
    v_cvt_pk_bf16_f32 v49, v66, v67
    s_waitcnt lgkmcnt(4)
    v_mfma_f32_32x32x16_bf16 v[80:95], v[24:27], v[112:115], 0
    ds_read_b128 v[40:43], v2 offset:22528
    ds_read_b128 v[44:47], v2 offset:23552
    v_exp_f32 v69, v69
    v_exp_f32 v70, v70
    v_cvt_pk_bf16_f32 v50, v68, v69
    s_add_u32 m0, s25, 1024
    s_add_u32 s57, s24, 99328
    buffer_load_dwordx4 v6, s[12:15], s57 offen sc1 lds
    v_exp_f32 v71, v71
    v_exp_f32 v72, v72
    v_cvt_pk_bf16_f32 v51, v70, v71
    v_mfma_f32_32x32x16_bf16 v[80:95], v[28:31], v[116:119], v[80:95]
    v_exp_f32 v73, v73
    v_exp_f32 v74, v74
    v_cvt_pk_bf16_f32 v52, v72, v73
    s_add_u32 s57, s28, 12288
    buffer_load_dwordx4 v[176:179], v6, s[12:15], s57 offen sc1
    v_exp_f32 v75, v75
    s_waitcnt lgkmcnt(4)
    v_mfma_f32_32x32x16_bf16 v[96:111], v[32:35], v[48:51], v[96:111]
    v_exp_f32 v76, v76
    v_cvt_pk_bf16_f32 v53, v74, v75
    v_exp_f32 v77, v77
    v_exp_f32 v78, v78
    v_cvt_pk_bf16_f32 v54, v76, v77
    v_exp_f32 v79, v79
    s_nop 0
    v_cvt_pk_bf16_f32 v55, v78, v79
    v_exp_f32 v80, v80
    v_exp_f32 v81, v81
    v_mfma_f32_32x32x16_bf16 v[96:111], v[36:39], v[52:55], v[96:111]
    ds_read_b128 v[24:27], v2 offset:36864
    ds_read_b128 v[28:31], v2 offset:37888
    v_exp_f32 v82, v82
    v_cvt_pk_bf16_f32 v48, v80, v81
    v_exp_f32 v83, v83
    s_add_u32 s57, s28, 13312
    buffer_load_dwordx4 v[180:183], v6, s[12:15], s57 offen sc1
    v_exp_f32 v84, v84
    v_cvt_pk_bf16_f32 v49, v82, v83
    s_waitcnt lgkmcnt(4)
    v_mfma_f32_32x32x16_bf16 v[64:79], v[16:19], v[112:115], 0
    ds_read_b128 v[32:35], v2 offset:34816
    ds_read_b128 v[36:39], v2 offset:35840
    v_exp_f32 v85, v85
    v_exp_f32 v86, v86
    v_cvt_pk_bf16_f32 v50, v84, v85
    s_add_u32 s57, s28, 14336
    buffer_load_dwordx4 v[184:187], v6, s[12:15], s57 offen sc1
    v_exp_f32 v87, v87
    v_exp_f32 v88, v88
    v_cvt_pk_bf16_f32 v51, v86, v87
    v_mfma_f32_32x32x16_bf16 v[64:79], v[20:23], v[116:119], v[64:79]
    v_exp_f32 v89, v89
    v_exp_f32 v90, v90
    v_cvt_pk_bf16_f32 v52, v88, v89
    s_add_u32 s57, s28, 15360
    buffer_load_dwordx4 v[188:191], v6, s[12:15], s57 offen sc1
    v_exp_f32 v91, v91
    s_waitcnt lgkmcnt(4)
    v_mfma_f32_32x32x16_bf16 v[96:111], v[40:43], v[48:51], v[96:111]
    v_exp_f32 v92, v92
    v_cvt_pk_bf16_f32 v53, v90, v91
    v_exp_f32 v93, v93
    v_exp_f32 v94, v94
    v_cvt_pk_bf16_f32 v54, v92, v93
    v_exp_f32 v95, v95
    s_nop 0
    v_cvt_pk_bf16_f32 v55, v94, v95
    s_waitcnt vmcnt(10)
    s_barrier
    v_exp_f32 v64, v64
    v_exp_f32 v65, v65
    v_mfma_f32_32x32x16_bf16 v[96:111], v[44:47], v[52:55], v[96:111]
    ds_read_b128 v[16:19], v2 offset:49152
    ds_read_b128 v[20:23], v2 offset:50176
    v_exp_f32 v66, v66
    v_cvt_pk_bf16_f32 v48, v64, v65
    v_exp_f32 v67, v67
    s_add_u32 m0, s25, 16384
    s_add_u32 s57, s24, 106496
    buffer_load_dwordx4 v6, s[12:15], s57 offen sc1 lds
    v_exp_f32 v68, v68
    v_cvt_pk_bf16_f32 v49, v66, v67
    s_waitcnt lgkmcnt(4)
    v_mfma_f32_32x32x16_bf16 v[80:95], v[24:27], v[112:115], 0
    ds_read_b128 v[40:43], v2 offset:38912
    ds_read_b128 v[44:47], v2 offset:39936
    v_exp_f32 v69, v69
    v_exp_f32 v70, v70
    v_cvt_pk_bf16_f32 v50, v68, v69
    s_add_u32 m0, s25, 17408
    s_add_u32 s57, s24, 107520
    buffer_load_dwordx4 v6, s[12:15], s57 offen sc1 lds
    v_exp_f32 v71, v71
    v_exp_f32 v72, v72
    v_cvt_pk_bf16_f32 v51, v70, v71
    v_mfma_f32_32x32x16_bf16 v[80:95], v[28:31], v[116:119], v[80:95]
    v_exp_f32 v73, v73
    v_exp_f32 v74, v74
    v_cvt_pk_bf16_f32 v52, v72, v73
    s_add_u32 s57, s28, 16384
    buffer_load_dwordx4 v[192:195], v6, s[12:15], s57 offen sc1
    v_exp_f32 v75, v75
    s_waitcnt lgkmcnt(4)
    v_mfma_f32_32x32x16_bf16 v[96:111], v[32:35], v[48:51], v[96:111]
    v_exp_f32 v76, v76
    v_cvt_pk_bf16_f32 v53, v74, v75
    v_exp_f32 v77, v77
    v_exp_f32 v78, v78
    v_cvt_pk_bf16_f32 v54, v76, v77
    v_exp_f32 v79, v79
    s_nop 0
    v_cvt_pk_bf16_f32 v55, v78, v79
    v_exp_f32 v80, v80
    v_exp_f32 v81, v81
    v_mfma_f32_32x32x16_bf16 v[96:111], v[36:39], v[52:55], v[96:111]
    ds_read_b128 v[24:27], v2 offset:53248
    ds_read_b128 v[28:31], v2 offset:54272
    v_exp_f32 v82, v82
    v_cvt_pk_bf16_f32 v48, v80, v81
    v_exp_f32 v83, v83
    s_add_u32 s57, s28, 17408
    buffer_load_dwordx4 v[196:199], v6, s[12:15], s57 offen sc1
    v_exp_f32 v84, v84
    v_cvt_pk_bf16_f32 v49, v82, v83
    s_waitcnt lgkmcnt(4)
    v_mfma_f32_32x32x16_bf16 v[64:79], v[16:19], v[112:115], 0
    ds_read_b128 v[32:35], v2 offset:51200
    ds_read_b128 v[36:39], v2 offset:52224
    v_exp_f32 v85, v85
    v_exp_f32 v86, v86
    v_cvt_pk_bf16_f32 v50, v84, v85
    s_add_u32 s57, s28, 18432
    buffer_load_dwordx4 v[200:203], v6, s[12:15], s57 offen sc1
    v_exp_f32 v87, v87
    v_exp_f32 v88, v88
    v_cvt_pk_bf16_f32 v51, v86, v87
    v_mfma_f32_32x32x16_bf16 v[64:79], v[20:23], v[116:119], v[64:79]
    v_exp_f32 v89, v89
    v_exp_f32 v90, v90
    v_cvt_pk_bf16_f32 v52, v88, v89
    v_exp_f32 v91, v91
    s_waitcnt lgkmcnt(4)
    v_mfma_f32_32x32x16_bf16 v[96:111], v[40:43], v[48:51], v[96:111]
    v_exp_f32 v92, v92
    v_cvt_pk_bf16_f32 v53, v90, v91
    v_exp_f32 v93, v93
    v_exp_f32 v94, v94
    v_cvt_pk_bf16_f32 v54, v92, v93
    v_exp_f32 v95, v95
    s_nop 0
    v_cvt_pk_bf16_f32 v55, v94, v95
    s_waitcnt vmcnt(9)
    s_barrier
    v_exp_f32 v64, v64
    v_exp_f32 v65, v65
    v_mfma_f32_32x32x16_bf16 v[96:111], v[44:47], v[52:55], v[96:111]
    ds_read_b128 v[16:19], v2 offset:0
    ds_read_b128 v[20:23], v2 offset:1024
    v_exp_f32 v66, v66
    v_cvt_pk_bf16_f32 v48, v64, v65
    v_exp_f32 v67, v67
    s_add_u32 m0, s25, 32768
    s_add_u32 s57, s24, 114688
    buffer_load_dwordx4 v6, s[12:15], s57 offen sc1 lds
    v_exp_f32 v68, v68
    v_cvt_pk_bf16_f32 v49, v66, v67
    s_waitcnt lgkmcnt(4)
    v_mfma_f32_32x32x16_bf16 v[80:95], v[24:27], v[112:115], 0
    ds_read_b128 v[40:43], v2 offset:55296
    ds_read_b128 v[44:47], v2 offset:56320
    v_exp_f32 v69, v69
    v_exp_f32 v70, v70
    v_cvt_pk_bf16_f32 v50, v68, v69
    s_add_u32 m0, s25, 33792
    s_add_u32 s57, s24, 115712
    buffer_load_dwordx4 v6, s[12:15], s57 offen sc1 lds
    v_exp_f32 v71, v71
    v_exp_f32 v72, v72
    v_cvt_pk_bf16_f32 v51, v70, v71
    v_mfma_f32_32x32x16_bf16 v[80:95], v[28:31], v[116:119], v[80:95]
    v_exp_f32 v73, v73
    v_exp_f32 v74, v74
    v_cvt_pk_bf16_f32 v52, v72, v73
    s_add_u32 s57, s28, 19456
    buffer_load_dwordx4 v[204:207], v6, s[12:15], s57 offen sc1
    v_exp_f32 v75, v75
    s_waitcnt lgkmcnt(4)
    v_mfma_f32_32x32x16_bf16 v[96:111], v[32:35], v[48:51], v[96:111]
    v_exp_f32 v76, v76
    v_cvt_pk_bf16_f32 v53, v74, v75
    v_exp_f32 v77, v77
    v_exp_f32 v78, v78
    v_cvt_pk_bf16_f32 v54, v76, v77
    v_exp_f32 v79, v79
    s_nop 0
    v_cvt_pk_bf16_f32 v55, v78, v79
    v_exp_f32 v80, v80
    v_exp_f32 v81, v81
    v_mfma_f32_32x32x16_bf16 v[96:111], v[36:39], v[52:55], v[96:111]
    ds_read_b128 v[24:27], v2 offset:4096
    ds_read_b128 v[28:31], v2 offset:5120
    v_exp_f32 v82, v82
    v_cvt_pk_bf16_f32 v48, v80, v81
    v_exp_f32 v83, v83
    s_add_u32 s57, s28, 20480
    buffer_load_dwordx4 v[208:211], v6, s[12:15], s57 offen sc1
    v_exp_f32 v84, v84
    v_cvt_pk_bf16_f32 v49, v82, v83
    s_waitcnt lgkmcnt(4)
    v_mfma_f32_32x32x16_bf16 v[64:79], v[16:19], v[112:115], 0
    ds_read_b128 v[32:35], v2 offset:2048
    ds_read_b128 v[36:39], v2 offset:3072
    v_exp_f32 v85, v85
    v_exp_f32 v86, v86
    v_cvt_pk_bf16_f32 v50, v84, v85
    s_add_u32 s57, s28, 21504
    buffer_load_dwordx4 v[212:215], v6, s[12:15], s57 offen sc1
    v_exp_f32 v87, v87
    v_exp_f32 v88, v88
    v_cvt_pk_bf16_f32 v51, v86, v87
    v_mfma_f32_32x32x16_bf16 v[64:79], v[20:23], v[116:119], v[64:79]
    v_exp_f32 v89, v89
    v_exp_f32 v90, v90
    v_cvt_pk_bf16_f32 v52, v88, v89
    v_exp_f32 v91, v91
    s_waitcnt lgkmcnt(4)
    v_mfma_f32_32x32x16_bf16 v[96:111], v[40:43], v[48:51], v[96:111]
    v_exp_f32 v92, v92
    v_cvt_pk_bf16_f32 v53, v90, v91
    v_exp_f32 v93, v93
    v_exp_f32 v94, v94
    v_cvt_pk_bf16_f32 v54, v92, v93
    v_exp_f32 v95, v95
    s_nop 0
    v_cvt_pk_bf16_f32 v55, v94, v95
    s_waitcnt vmcnt(8)
    s_barrier
    v_exp_f32 v64, v64
    v_exp_f32 v65, v65
    v_mfma_f32_32x32x16_bf16 v[96:111], v[44:47], v[52:55], v[96:111]
    ds_read_b128 v[16:19], v2 offset:16384
    ds_read_b128 v[20:23], v2 offset:17408
    v_exp_f32 v66, v66
    v_cvt_pk_bf16_f32 v48, v64, v65
    v_exp_f32 v67, v67
    s_add_u32 m0, s25, 49152
    s_add_u32 s57, s24, 122880
    buffer_load_dwordx4 v6, s[12:15], s57 offen sc1 lds
    v_exp_f32 v68, v68
    v_cvt_pk_bf16_f32 v49, v66, v67
    s_waitcnt lgkmcnt(4)
    v_mfma_f32_32x32x16_bf16 v[80:95], v[24:27], v[112:115], 0
    ds_read_b128 v[40:43], v2 offset:6144
    ds_read_b128 v[44:47], v2 offset:7168
    v_exp_f32 v69, v69
    v_exp_f32 v70, v70
    v_cvt_pk_bf16_f32 v50, v68, v69
    s_add_u32 m0, s25, 50176
    s_add_u32 s57, s24, 123904
    buffer_load_dwordx4 v6, s[12:15], s57 offen sc1 lds
    v_exp_f32 v71, v71
    v_exp_f32 v72, v72
    v_cvt_pk_bf16_f32 v51, v70, v71
    v_mfma_f32_32x32x16_bf16 v[80:95], v[28:31], v[116:119], v[80:95]
    v_exp_f32 v73, v73
    v_exp_f32 v74, v74
    v_cvt_pk_bf16_f32 v52, v72, v73
    s_add_u32 s57, s28, 22528
    buffer_load_dwordx4 v[216:219], v6, s[12:15], s57 offen sc1
    v_exp_f32 v75, v75
    s_waitcnt lgkmcnt(4)
    v_mfma_f32_32x32x16_bf16 v[96:111], v[32:35], v[48:51], v[96:111]
    v_exp_f32 v76, v76
    v_cvt_pk_bf16_f32 v53, v74, v75
    v_exp_f32 v77, v77
    v_exp_f32 v78, v78
    v_cvt_pk_bf16_f32 v54, v76, v77
    v_exp_f32 v79, v79
    s_nop 0
    v_cvt_pk_bf16_f32 v55, v78, v79
    v_exp_f32 v80, v80
    v_exp_f32 v81, v81
    v_mfma_f32_32x32x16_bf16 v[96:111], v[36:39], v[52:55], v[96:111]
    ds_read_b128 v[24:27], v2 offset:20480
    ds_read_b128 v[28:31], v2 offset:21504
    v_exp_f32 v82, v82
    v_cvt_pk_bf16_f32 v48, v80, v81
    v_exp_f32 v83, v83
    s_add_u32 s57, s28, 23552
    buffer_load_dwordx4 v[220:223], v6, s[12:15], s57 offen sc1
    v_exp_f32 v84, v84
    v_cvt_pk_bf16_f32 v49, v82, v83
    s_waitcnt lgkmcnt(4)
    v_mfma_f32_32x32x16_bf16 v[64:79], v[16:19], v[112:115], 0
    ds_read_b128 v[32:35], v2 offset:18432
    ds_read_b128 v[36:39], v2 offset:19456
    v_exp_f32 v85, v85
    v_exp_f32 v86, v86
    v_cvt_pk_bf16_f32 v50, v84, v85
    s_add_u32 s57, s28, 24576
    buffer_load_dwordx4 v[224:227], v6, s[12:15], s57 offen sc1
    v_exp_f32 v87, v87
    v_exp_f32 v88, v88
    v_cvt_pk_bf16_f32 v51, v86, v87
    v_mfma_f32_32x32x16_bf16 v[64:79], v[20:23], v[116:119], v[64:79]
    v_exp_f32 v89, v89
    v_exp_f32 v90, v90
    v_cvt_pk_bf16_f32 v52, v88, v89
    v_exp_f32 v91, v91
    s_waitcnt lgkmcnt(4)
    v_mfma_f32_32x32x16_bf16 v[96:111], v[40:43], v[48:51], v[96:111]
    v_exp_f32 v92, v92
    v_cvt_pk_bf16_f32 v53, v90, v91
    v_exp_f32 v93, v93
    v_exp_f32 v94, v94
    v_cvt_pk_bf16_f32 v54, v92, v93
    v_exp_f32 v95, v95
    s_nop 0
    v_cvt_pk_bf16_f32 v55, v94, v95
    s_waitcnt vmcnt(8)
    s_barrier
    v_exp_f32 v64, v64
    v_exp_f32 v65, v65
    v_mfma_f32_32x32x16_bf16 v[96:111], v[44:47], v[52:55], v[96:111]
    ds_read_b128 v[16:19], v2 offset:32768
    ds_read_b128 v[20:23], v2 offset:33792
    v_exp_f32 v66, v66
    v_cvt_pk_bf16_f32 v48, v64, v65
    v_exp_f32 v67, v67
    s_add_u32 s57, s28, 25600
    buffer_load_dwordx4 v[228:231], v6, s[12:15], s57 offen sc1
    v_exp_f32 v68, v68
    v_cvt_pk_bf16_f32 v49, v66, v67
    s_waitcnt lgkmcnt(4)
    v_mfma_f32_32x32x16_bf16 v[80:95], v[24:27], v[112:115], 0
    ds_read_b128 v[40:43], v2 offset:22528
    ds_read_b128 v[44:47], v2 offset:23552
    v_exp_f32 v69, v69
    v_exp_f32 v70, v70
    v_cvt_pk_bf16_f32 v50, v68, v69
    s_add_u32 s57, s28, 26624
    buffer_load_dwordx4 v[232:235], v6, s[12:15], s57 offen sc1
    v_exp_f32 v71, v71
    v_exp_f32 v72, v72
    v_cvt_pk_bf16_f32 v51, v70, v71
    v_mfma_f32_32x32x16_bf16 v[80:95], v[28:31], v[116:119], v[80:95]
    v_exp_f32 v73, v73
    v_exp_f32 v74, v74
    v_cvt_pk_bf16_f32 v52, v72, v73
    v_exp_f32 v75, v75
    s_waitcnt lgkmcnt(4)
    v_mfma_f32_32x32x16_bf16 v[96:111], v[32:35], v[48:51], v[96:111]
    v_exp_f32 v76, v76
    v_cvt_pk_bf16_f32 v53, v74, v75
    v_exp_f32 v77, v77
    v_exp_f32 v78, v78
    v_cvt_pk_bf16_f32 v54, v76, v77
    v_exp_f32 v79, v79
    s_nop 0
    v_cvt_pk_bf16_f32 v55, v78, v79
    v_exp_f32 v80, v80
    v_exp_f32 v81, v81
    v_mfma_f32_32x32x16_bf16 v[96:111], v[36:39], v[52:55], v[96:111]
    ds_read_b128 v[24:27], v2 offset:36864
    ds_read_b128 v[28:31], v2 offset:37888
    v_exp_f32 v82, v82
    v_cvt_pk_bf16_f32 v48, v80, v81
    v_exp_f32 v83, v83
    s_add_u32 s57, s28, 27648
    buffer_load_dwordx4 v[236:239], v6, s[12:15], s57 offen sc1
    v_exp_f32 v84, v84
    v_cvt_pk_bf16_f32 v49, v82, v83
    s_waitcnt lgkmcnt(4)
    v_mfma_f32_32x32x16_bf16 v[64:79], v[16:19], v[112:115], 0
    ds_read_b128 v[32:35], v2 offset:34816
    ds_read_b128 v[36:39], v2 offset:35840
    v_exp_f32 v85, v85
    v_exp_f32 v86, v86
    v_cvt_pk_bf16_f32 v50, v84, v85
    v_exp_f32 v87, v87
    v_exp_f32 v88, v88
    v_cvt_pk_bf16_f32 v51, v86, v87
    v_mfma_f32_32x32x16_bf16 v[64:79], v[20:23], v[116:119], v[64:79]
    v_exp_f32 v89, v89
    v_exp_f32 v90, v90
    v_cvt_pk_bf16_f32 v52, v88, v89
    v_exp_f32 v91, v91
    s_waitcnt lgkmcnt(4)
    v_mfma_f32_32x32x16_bf16 v[96:111], v[40:43], v[48:51], v[96:111]
    v_exp_f32 v92, v92
    v_cvt_pk_bf16_f32 v53, v90, v91
    v_exp_f32 v93, v93
    v_exp_f32 v94, v94
    v_cvt_pk_bf16_f32 v54, v92, v93
    v_exp_f32 v95, v95
    s_nop 0
    v_cvt_pk_bf16_f32 v55, v94, v95
    s_waitcnt vmcnt(6)
    s_barrier
    v_exp_f32 v64, v64
    v_exp_f32 v65, v65
    v_mfma_f32_32x32x16_bf16 v[96:111], v[44:47], v[52:55], v[96:111]
    ds_read_b128 v[16:19], v2 offset:49152
    ds_read_b128 v[20:23], v2 offset:50176
    v_exp_f32 v66, v66
    v_cvt_pk_bf16_f32 v48, v64, v65
    v_exp_f32 v67, v67
    buffer_load_dwordx2 v[240:241], v11, s[4:7], 0 offen
    v_exp_f32 v68, v68
    v_cvt_pk_bf16_f32 v49, v66, v67
    s_waitcnt lgkmcnt(4)
    v_mfma_f32_32x32x16_bf16 v[80:95], v[24:27], v[112:115], 0
    ds_read_b128 v[40:43], v2 offset:38912
    ds_read_b128 v[44:47], v2 offset:39936
    v_exp_f32 v69, v69
    v_exp_f32 v70, v70
    v_cvt_pk_bf16_f32 v50, v68, v69
    buffer_load_dwordx2 v[242:243], v11, s[4:7], 0 offen offset:16
    v_exp_f32 v71, v71
    v_exp_f32 v72, v72
    v_cvt_pk_bf16_f32 v51, v70, v71
    v_mfma_f32_32x32x16_bf16 v[80:95], v[28:31], v[116:119], v[80:95]
    v_exp_f32 v73, v73
    v_exp_f32 v74, v74
    v_cvt_pk_bf16_f32 v52, v72, v73
    v_exp_f32 v75, v75
    s_waitcnt lgkmcnt(4)
    v_mfma_f32_32x32x16_bf16 v[96:111], v[32:35], v[48:51], v[96:111]
    v_exp_f32 v76, v76
    v_cvt_pk_bf16_f32 v53, v74, v75
    v_exp_f32 v77, v77
    v_exp_f32 v78, v78
    v_cvt_pk_bf16_f32 v54, v76, v77
    v_exp_f32 v79, v79
    s_nop 0
    v_cvt_pk_bf16_f32 v55, v78, v79
    v_exp_f32 v80, v80
    v_exp_f32 v81, v81
    v_mfma_f32_32x32x16_bf16 v[96:111], v[36:39], v[52:55], v[96:111]
    ds_read_b128 v[24:27], v2 offset:53248
    ds_read_b128 v[28:31], v2 offset:54272
    v_exp_f32 v82, v82
    v_cvt_pk_bf16_f32 v48, v80, v81
    v_exp_f32 v83, v83
    buffer_load_dwordx2 v[244:245], v15, s[80:83], 0 offen
    v_exp_f32 v84, v84
    v_cvt_pk_bf16_f32 v49, v82, v83
    s_waitcnt lgkmcnt(4)
    v_mfma_f32_32x32x16_bf16 v[64:79], v[16:19], v[112:115], 0
    ds_read_b128 v[32:35], v2 offset:51200
    ds_read_b128 v[36:39], v2 offset:52224
    v_exp_f32 v85, v85
    v_exp_f32 v86, v86
    v_cvt_pk_bf16_f32 v50, v84, v85
    buffer_load_dwordx2 v[246:247], v15, s[80:83], 0 offen offset:16
    v_exp_f32 v87, v87
    v_exp_f32 v88, v88
    v_cvt_pk_bf16_f32 v51, v86, v87
    v_mfma_f32_32x32x16_bf16 v[64:79], v[20:23], v[116:119], v[64:79]
    v_exp_f32 v89, v89
    v_exp_f32 v90, v90
    v_cvt_pk_bf16_f32 v52, v88, v89
    v_exp_f32 v91, v91
    s_waitcnt lgkmcnt(4)
    v_mfma_f32_32x32x16_bf16 v[96:111], v[40:43], v[48:51], v[96:111]
    v_exp_f32 v92, v92
    v_cvt_pk_bf16_f32 v53, v90, v91
    v_exp_f32 v93, v93
    v_exp_f32 v94, v94
    v_cvt_pk_bf16_f32 v54, v92, v93
    v_exp_f32 v95, v95
    s_nop 0
    v_cvt_pk_bf16_f32 v55, v94, v95
    v_exp_f32 v64, v64
    v_exp_f32 v65, v65
    v_mfma_f32_32x32x16_bf16 v[96:111], v[44:47], v[52:55], v[96:111]
    ds_read_b128 v[16:19], v2 offset:53248
    ds_read_b128 v[20:23], v2 offset:54272
    v_exp_f32 v66, v66
    v_cvt_pk_bf16_f32 v48, v64, v65
    v_exp_f32 v67, v67
    v_exp_f32 v68, v68
    v_cvt_pk_bf16_f32 v49, v66, v67
    s_waitcnt lgkmcnt(4)
    v_mfma_f32_32x32x16_bf16 v[80:95], v[24:27], v[112:115], 0
    ds_read_b128 v[40:43], v2 offset:55296
    ds_read_b128 v[44:47], v2 offset:56320
    v_exp_f32 v69, v69
    v_exp_f32 v70, v70
    v_cvt_pk_bf16_f32 v50, v68, v69
    v_exp_f32 v71, v71
    v_exp_f32 v72, v72
    v_cvt_pk_bf16_f32 v51, v70, v71
    v_mfma_f32_32x32x16_bf16 v[80:95], v[28:31], v[116:119], v[80:95]
    v_exp_f32 v73, v73
    v_exp_f32 v74, v74
    v_cvt_pk_bf16_f32 v52, v72, v73
    v_exp_f32 v75, v75
    s_waitcnt lgkmcnt(4)
    v_mfma_f32_32x32x16_bf16 v[96:111], v[32:35], v[48:51], v[96:111]
    v_exp_f32 v76, v76
    v_cvt_pk_bf16_f32 v53, v74, v75
    v_exp_f32 v77, v77
    v_exp_f32 v78, v78
    v_cvt_pk_bf16_f32 v54, v76, v77
    v_exp_f32 v79, v79
    s_nop 0
    v_cvt_pk_bf16_f32 v55, v78, v79
    v_exp_f32 v80, v80
    v_exp_f32 v81, v81
    v_mfma_f32_32x32x16_bf16 v[96:111], v[36:39], v[52:55], v[96:111]
    ds_read_b128 v[24:27], v2 offset:53248
    ds_read_b128 v[28:31], v2 offset:54272
    v_exp_f32 v82, v82
    v_cvt_pk_bf16_f32 v48, v80, v81
    v_exp_f32 v83, v83
    v_exp_f32 v84, v84
    v_cvt_pk_bf16_f32 v49, v82, v83
    s_waitcnt lgkmcnt(4)
    v_mfma_f32_32x32x16_bf16 v[64:79], v[16:19], v[112:115], 0
    ds_read_b128 v[32:35], v2 offset:55296
    ds_read_b128 v[36:39], v2 offset:56320
    v_exp_f32 v85, v85
    v_exp_f32 v86, v86
    v_cvt_pk_bf16_f32 v50, v84, v85
    v_exp_f32 v87, v87
    v_exp_f32 v88, v88
    v_cvt_pk_bf16_f32 v51, v86, v87
    v_mfma_f32_32x32x16_bf16 v[64:79], v[20:23], v[116:119], v[64:79]
    v_exp_f32 v89, v89
    v_exp_f32 v90, v90
    v_cvt_pk_bf16_f32 v52, v88, v89
    v_exp_f32 v91, v91
    s_waitcnt lgkmcnt(4)
    v_mfma_f32_32x32x16_bf16 v[96:111], v[40:43], v[48:51], v[96:111]
    v_exp_f32 v92, v92
    v_cvt_pk_bf16_f32 v53, v90, v91
    v_exp_f32 v93, v93
    v_exp_f32 v94, v94
    v_cvt_pk_bf16_f32 v54, v92, v93
    v_exp_f32 v95, v95
    s_nop 0
    v_cvt_pk_bf16_f32 v55, v94, v95
    s_waitcnt lgkmcnt(0)
    s_nop 1
    v_mfma_f32_32x32x16_bf16 v[96:111], v[44:47], v[52:55], v[96:111]
    s_mov_b32 s62, 1
C_XCH:
    s_lshl_b32 s57, s22, 12
    s_add_u32 s57, s57, 16384
    v_add_u32 v7, s57, v6
    s_lshl_b32 s57, s20, 2
    s_add_u32 s57, s57, s22
    s_lshl_b32 s60, s57, 8
    s_lshl_b32 s58, s21, 2
    s_add_u32 s60, s60, s58
    s_add_u32 s60, s60, 17317888
    s_lshl_b32 s57, s57, 4
    s_add_u32 s57, s57, s21
    s_lshl_b32 s57, s57, 11
    s_add_u32 s61, s57, 13631488
    s_cmp_eq_u32 s26, 0
    s_cselect_b32 s61, s61, 0x7fffff00
    s_cbranch_scc1 C_LO
    ds_write_b128 v7, v[96:99] offset:0
    ds_write_b128 v7, v[100:103] offset:1024
    ds_write_b128 v7, v[104:107] offset:2048
    ds_write_b128 v7, v[108:111] offset:3072
    s_waitcnt lgkmcnt(0)
    s_barrier
    s_branch C_DONE
C_LO:
    s_barrier
    ds_read_b128 v[64:67], v7 offset:0
    ds_read_b128 v[68:71], v7 offset:1024
    ds_read_b128 v[72:75], v7 offset:2048
    ds_read_b128 v[76:79], v7 offset:3072
    s_waitcnt lgkmcnt(0)
    v_add_f32 v96, v96, v64
    v_add_f32 v97, v97, v65
    v_add_f32 v98, v98, v66
    v_add_f32 v99, v99, v67
    v_add_f32 v100, v100, v68
    v_add_f32 v101, v101, v69
    v_add_f32 v102, v102, v70
    v_add_f32 v103, v103, v71
    v_add_f32 v104, v104, v72
    v_add_f32 v105, v105, v73
    v_add_f32 v106, v106, v74
    v_add_f32 v107, v107, v75
    v_add_f32 v108, v108, v76
    v_add_f32 v109, v109, v77
    v_add_f32 v110, v110, v78
    v_add_f32 v111, v111, v79
    v_mov_b32 v57, v108
    v_mov_b32 v58, v108
    s_nop 1
    v_permlane32_swap_b32 v57, v58
    v_max3_f32 v60, |v96|, |v97|, |v98|
    v_max3_f32 v60, v60, |v99|, |v100|
    v_max3_f32 v60, v60, |v101|, |v102|
    v_max3_f32 v60, v60, |v103|, |v104|
    v_max3_f32 v60, v60, |v105|, |v106|
    v_max3_f32 v60, v60, |v107|, |v108|
    v_max3_f32 v60, v60, |v109|, |v110|
    v_max_f32 v60, v60, |v111|
    v_cmp_nge_f32 vcc, 0x4e800000, v58
    v_mov_b32 v61, 0x7b800000
    v_cmp_nge_f32 s[58:59], v61, v60
    s_nop 0
    s_or_b64 vcc, vcc, s[58:59]
    s_cmp_lg_u64 vcc, 0
    s_cselect_b32 s57, 1, 0
    s_and_b32 s57, s57, s62
    v_mov_b32 v61, s57
    s_lshl_b32 s58, s22, 2
    s_add_u32 s58, s58, 32768
    v_mov_b32 v60, s58
    ds_write_b32 v60, v61
    v_rcp_f32 v58, v58
    v_cmp_gt_u32 vcc, 32, v1
    s_nop 1
    v_cndmask_b32 v59, 0, v58, vcc
    v_mul_f32 v96, v58, v96
    v_mul_f32 v97, v58, v97
    v_mul_f32 v98, v58, v98
    v_mul_f32 v99, v58, v99
    v_mul_f32 v100, v58, v100
    v_mul_f32 v101, v58, v101
    v_mul_f32 v102, v58, v102
    v_mul_f32 v103, v58, v103
    v_mul_f32 v104, v58, v104
    v_mul_f32 v105, v58, v105
    v_mul_f32 v106, v58, v106
    v_mul_f32 v107, v58, v107
    v_mul_f32 v108, v59, v108
    v_mul_f32 v109, v59, v109
    v_mul_f32 v110, v59, v110
    v_mul_f32 v111, v59, v111
    v_cvt_pk_bf16_f32 v56, v96, v97
    v_cvt_pk_bf16_f32 v57, v98, v99
    v_cvt_pk_bf16_f32 v58, v100, v101
    v_cvt_pk_bf16_f32 v59, v102, v103
    v_cvt_pk_bf16_f32 v60, v104, v105
    v_cvt_pk_bf16_f32 v61, v106, v107
    v_cvt_pk_bf16_f32 v62, v108, v109
    v_cvt_pk_bf16_f32 v63, v110, v111
C_DONE:
    buffer_store_dwordx4 v[56:59], v6, s[12:15], s61 offen sc1
    buffer_store_dwordx4 v[60:63], v6, s[12:15], s61 offen offset:1024 sc1
    s_waitcnt lgkmcnt(0)
    s_barrier
    v_and_b32 v60, 3, v1
    v_lshlrev_b32 v60, 2, v60
    v_add_u32 v60, 32768, v60
    ds_read_b32 v61, v60
    s_waitcnt lgkmcnt(0)
    v_cmp_ne_u32 vcc, 0, v61
    s_nop 1
    s_cmp_lg_u64 vcc, 0
    s_cbranch_scc1 C_SLOW
    s_cmp_eq_u32 s43, 7
    s_cbranch_scc0 IDLE_28
    s_waitcnt vmcnt(0)
    s_cmp_eq_u32 s26, 0
    s_cbranch_scc0 K_END
    v_mov_b32 v56, s56
    v_mov_b32 v57, 0
    s_mov_b64 s[58:59], exec
    s_mov_b64 exec, 1
    buffer_store_dword v56, v57, s[12:15], s60 offen sc0 sc1
    s_mov_b64 exec, s[58:59]
    s_branch K_END
C_SLOW:
    s_waitcnt vmcnt(0)
    s_barrier
    s_mov_b32 s62, 0
    v_cmp_le_u32 s[64:65], 32, v1
    v_mov_b32 v57, 0
    s_nop 0
    v_cndmask_b32 v118, v118, v57, s[64:65]
    v_cndmask_b32 v119, v119, v57, s[64:65]
    s_lshl_b32 s66, s21, 6
    s_lshl_b32 s57, s26, 5
    s_add_u32 s66, s66, s57
    s_lshl_b32 s66, s66, 12
    s_add_u32 s66, s66, 2097152
    v_mov_b32 v56, 0xff800000
    s_mov_b32 s67, 0
SL1:
    s_lshl_b32 s57, s67, 12
    s_add_u32 s57, s57, s66
    buffer_load_dwordx4 v[16:19], v6, s[12:15], s57 offen sc1
    buffer_load_dwordx4 v[20:23], v6, s[12:15], s57 offen offset:1024 sc1
    s_waitcnt vmcnt(0)
    v_mfma_f32_32x32x16_bf16 v[64:79], v[16:19], v[112:115], 0
    v_mfma_f32_32x32x16_bf16 v[64:79], v[20:23], v[116:119], v[64:79]
    s_nop 11
    v_max3_f32 v56, v56, v64, v65
    v_max3_f32 v56, v56, v66, v67
    v_max3_f32 v56, v56, v68, v69
    v_max3_f32 v56, v56, v70, v71
    v_max3_f32 v56, v56, v72, v73
    v_max3_f32 v56, v56, v74, v75
    v_max3_f32 v56, v56, v76, v77
    v_max3_f32 v56, v56, v78, v79
    s_add_u32 s67, s67, 1
    s_cmp_lt_u32 s67, 32
    s_cbranch_scc1 SL1
    v_mov_b32 v57, v56
    v_mov_b32 v58, v56
    s_nop 1
    v_permlane32_swap_b32 v57, v58
    v_max_f32 v56, v57, v58
    s_lshl_b32 s57, s3, 8
    v_lshlrev_b32 v57, 2, v1
    v_add_u32 v58, s57, v57
    ds_write_b32 v58, v56
    s_waitcnt lgkmcnt(0)
    s_barrier
    s_xor_b32 s57, s3, 4
    s_lshl_b32 s57, s57, 8
    v_add_u32 v58, s57, v57
    ds_read_b32 v57, v58
    s_waitcnt lgkmcnt(0)
    v_max_f32 v56, v56, v57
    s_barrier
    v_cvt_pk_bf16_f32 v57, v56, v56
    v_and_b32 v57, 0xffff0000, v57
    v_sub_f32 v58, v56, v57
    v_cvt_pk_bf16_f32 v59, v58, v58
    v_and_b32 v59, 0xffff0000, v59
    v_sub_f32 v58, v58, v59
    v_cvt_pk_bf16_f32 v60, -v57, -v59
    v_mov_b32 v61, 0
    v_cvt_pk_bf16_f32 v61, -v58, v61
    v_cmp_le_u32 vcc, 32, v1
    s_nop 1
    v_cndmask_b32 v118, v118, v60, vcc
    v_cndmask_b32 v119, v119, v61, vcc
    v_mov_b32 v96, 0
    v_mov_b32 v97, 0
    v_mov_b32 v98, 0
    v_mov_b32 v99, 0
    v_mov_b32 v100, 0
    v_mov_b32 v101, 0
    v_mov_b32 v102, 0
    v_mov_b32 v103, 0
    v_mov_b32 v104, 0
    v_mov_b32 v105, 0
    v_mov_b32 v106, 0
    v_mov_b32 v107, 0
    v_mov_b32 v108, 0
    v_mov_b32 v109, 0
    v_mov_b32 v110, 0
    v_mov_b32 v111, 0
    s_mov_b32 s67, 0
SL2:
    s_lshl_b32 s57, s67, 12
    s_add_u32 s57, s57, s66
    buffer_load_dwordx4 v[16:19], v6, s[12:15], s57 offen sc1
    buffer_load_dwordx4 v[20:23], v6, s[12:15], s57 offen offset:1024 sc1
    buffer_load_dwordx4 v[32:35], v6, s[12:15], s57 offen offset:2048 sc1
    buffer_load_dwordx4 v[36:39], v6, s[12:15], s57 offen offset:3072 sc1
    s_waitcnt vmcnt(0)
    v_mfma_f32_32x32x16_bf16 v[64:79], v[16:19], v[112:115], 0
    v_mfma_f32_32x32x16_bf16 v[64:79], v[20:23], v[116:119], v[64:79]
    s_nop 11
    v_exp_f32 v64, v64
    v_exp_f32 v65, v65
    v_exp_f32 v66, v66
    v_exp_f32 v67, v67
    v_exp_f32 v68, v68
    v_exp_f32 v69, v69
    v_exp_f32 v70, v70
    v_exp_f32 v71, v71
    v_exp_f32 v72, v72
    v_exp_f32 v73, v73
    v_exp_f32 v74, v74
    v_exp_f32 v75, v75
    v_exp_f32 v76, v76
    v_exp_f32 v77, v77
    v_exp_f32 v78, v78
    v_exp_f32 v79, v79
    v_cvt_pk_bf16_f32 v48, v64, v65
    v_cvt_pk_bf16_f32 v49, v66, v67
    v_cvt_pk_bf16_f32 v50, v68, v69
    v_cvt_pk_bf16_f32 v51, v70, v71
    v_cvt_pk_bf16_f32 v52, v72, v73
    v_cvt_pk_bf16_f32 v53, v74, v75
    v_cvt_pk_bf16_f32 v54, v76, v77
    v_cvt_pk_bf16_f32 v55, v78, v79
    v_mfma_f32_32x32x16_bf16 v[96:111], v[32:35], v[48:51], v[96:111]
    s_nop 0
    v_mfma_f32_32x32x16_bf16 v[96:111], v[36:39], v[52:55], v[96:111]
    s_add_u32 s67, s67, 1
    s_cmp_lt_u32 s67, 32
    s_cbranch_scc1 SL2
    s_nop 15
    s_branch C_XCH
IDLE_28:
    v_mov_b32 v64, 0
    v_mov_b32 v65, 0
    v_mov_b32 v66, 0
    v_mov_b32 v67, 0
    v_mov_b32 v68, 0
    v_mov_b32 v69, 0
    v_mov_b32 v70, 0
    v_mov_b32 v71, 0
    v_mov_b32 v72, 0
    v_mov_b32 v73, 0
    v_mov_b32 v74, 0
    v_mov_b32 v75, 0
    v_mov_b32 v76, 0
    v_mov_b32 v77, 0
    v_mov_b32 v78, 0
    v_mov_b32 v79, 0
    v_mov_b32 v80, 0
    v_mov_b32 v81, 0
    v_mov_b32 v82, 0
    v_mov_b32 v83, 0
    v_mov_b32 v84, 0
    v_mov_b32 v85, 0
    v_mov_b32 v86, 0
    v_mov_b32 v87, 0
    v_mov_b32 v88, 0
    v_mov_b32 v89, 0
    v_mov_b32 v90, 0
    v_mov_b32 v91, 0
    v_mov_b32 v92, 0
    v_mov_b32 v93, 0
    v_mov_b32 v94, 0
    v_mov_b32 v95, 0
    s_waitcnt vmcnt(6)
    ds_read_b64_tr_b16 v[16:17], v13 offset:0
    ds_read_b64_tr_b16 v[18:19], v13 offset:1024
    ds_read_b64_tr_b16 v[20:21], v13 offset:256
    ds_read_b64_tr_b16 v[22:23], v13 offset:1280
    ds_read_b64_tr_b16 v[24:25], v13 offset:2048
    ds_read_b64_tr_b16 v[26:27], v13 offset:3072
    ds_read_b64_tr_b16 v[28:29], v13 offset:2304
    ds_read_b64_tr_b16 v[30:31], v13 offset:3328
    ds_read_b64_tr_b16 v[32:33], v13 offset:4096
    ds_read_b64_tr_b16 v[34:35], v13 offset:5120
    ds_read_b64_tr_b16 v[36:37], v13 offset:4352
    ds_read_b64_tr_b16 v[38:39], v13 offset:5376
    ds_read_b64_tr_b16 v[40:41], v13 offset:6144
    ds_read_b64_tr_b16 v[42:43], v13 offset:7168
    ds_read_b64_tr_b16 v[44:45], v13 offset:6400
    ds_read_b64_tr_b16 v[46:47], v13 offset:7424
    ds_read_b64_tr_b16 v[48:49], v13 offset:32768
    ds_read_b64_tr_b16 v[50:51], v13 offset:33792
    ds_read_b64_tr_b16 v[52:53], v13 offset:33024
    ds_read_b64_tr_b16 v[54:55], v13 offset:34048
    s_waitcnt lgkmcnt(15)
    v_mfma_f32_32x32x16_bf16 v[64:79], v[16:19], v[128:131], v[64:79]
    s_add_u32 m0, s33, 0
    s_add_u32 s57, s30, 172032
    buffer_load_dwordx4 v5, s[8:11], s57 offen lds
    s_add_u32 m0, s33, 1024
    s_add_u32 s57, s30, 179200
    buffer_load_dwordx4 v5, s[8:11], s57 offen lds
    v_mfma_f32_32x32x16_bf16 v[80:95], v[20:23], v[128:131], v[80:95]
    s_add_u32 m0, s33, 2048
    s_add_u32 s57, s30, 186368
    buffer_load_dwordx4 v5, s[8:11], s57 offen lds
    s_add_u32 m0, s33, 3072
    s_add_u32 s57, s30, 193536
    buffer_load_dwordx4 v5, s[8:11], s57 offen lds
    ds_read_b64_tr_b16 v[16:17], v13 offset:34816
    ds_read_b64_tr_b16 v[18:19], v13 offset:35840
    ds_read_b64_tr_b16 v[20:21], v13 offset:35072
    ds_read_b64_tr_b16 v[22:23], v13 offset:36096
    s_waitcnt lgkmcnt(15)
    v_mfma_f32_32x32x16_bf16 v[64:79], v[24:27], v[132:135], v[64:79]
    v_mfma_f32_32x32x16_bf16 v[80:95], v[28:31], v[132:135], v[80:95]
    ds_read_b64_tr_b16 v[24:25], v13 offset:36864
    ds_read_b64_tr_b16 v[26:27], v13 offset:37888
    ds_read_b64_tr_b16 v[28:29], v13 offset:37120
    ds_read_b64_tr_b16 v[30:31], v13 offset:38144
    s_waitcnt lgkmcnt(15)
    v_mfma_f32_32x32x16_bf16 v[64:79], v[32:35], v[136:139], v[64:79]
    v_mfma_f32_32x32x16_bf16 v[80:95], v[36:39], v[136:139], v[80:95]
    ds_read_b64_tr_b16 v[32:33], v13 offset:38912
    ds_read_b64_tr_b16 v[34:35], v13 offset:39936
    ds_read_b64_tr_b16 v[36:37], v13 offset:39168
    ds_read_b64_tr_b16 v[38:39], v13 offset:40192
    s_waitcnt lgkmcnt(15)
    v_mfma_f32_32x32x16_bf16 v[64:79], v[40:43], v[140:143], v[64:79]
    v_mfma_f32_32x32x16_bf16 v[80:95], v[44:47], v[140:143], v[80:95]
    s_barrier
    ds_read_b64_tr_b16 v[40:41], v14 offset:0
    ds_read_b64_tr_b16 v[42:43], v14 offset:1024
    ds_read_b64_tr_b16 v[44:45], v14 offset:256
    ds_read_b64_tr_b16 v[46:47], v14 offset:1280
    s_waitcnt lgkmcnt(15)
    v_mfma_f32_32x32x16_bf16 v[64:79], v[48:51], v[144:147], v[64:79]
    s_add_u32 m0, s33, 32768
    s_add_u32 s57, s30, 229376
    buffer_load_dwordx4 v5, s[8:11], s57 offen lds
    s_add_u32 m0, s33, 33792
    s_add_u32 s57, s30, 236544
    buffer_load_dwordx4 v5, s[8:11], s57 offen lds
    s_add_u32 m0, s33, 34816
    s_add_u32 s57, s30, 243712
    buffer_load_dwordx4 v5, s[8:11], s57 offen lds
    s_add_u32 m0, s33, 35840
    s_add_u32 s57, s30, 250880
    buffer_load_dwordx4 v5, s[8:11], s57 offen lds
    v_mfma_f32_32x32x16_bf16 v[80:95], v[52:55], v[144:147], v[80:95]
    s_add_u32 m0, s33, 65536
    s_add_u32 s57, s30, 286720
    buffer_load_dwordx4 v5, s[8:11], s57 offen lds
    s_add_u32 m0, s33, 66560
    s_add_u32 s57, s30, 293888
    buffer_load_dwordx4 v5, s[8:11], s57 offen lds
    s_add_u32 m0, s33, 67584
    s_add_u32 s57, s30, 301056
    buffer_load_dwordx4 v5, s[8:11], s57 offen lds
    s_add_u32 m0, s33, 68608
    s_add_u32 s57, s30, 308224
    buffer_load_dwordx4 v5, s[8:11], s57 offen lds
    ds_read_b64_tr_b16 v[48:49], v14 offset:2048
    ds_read_b64_tr_b16 v[50:51], v14 offset:3072
    ds_read_b64_tr_b16 v[52:53], v14 offset:2304
    ds_read_b64_tr_b16 v[54:55], v14 offset:3328
    s_waitcnt lgkmcnt(15)
    v_mfma_f32_32x32x16_bf16 v[64:79], v[16:19], v[148:151], v[64:79]
    v_mfma_f32_32x32x16_bf16 v[80:95], v[20:23], v[148:151], v[80:95]
    ds_read_b64_tr_b16 v[16:17], v14 offset:4096
    ds_read_b64_tr_b16 v[18:19], v14 offset:5120
    ds_read_b64_tr_b16 v[20:21], v14 offset:4352
    ds_read_b64_tr_b16 v[22:23], v14 offset:5376
    s_waitcnt lgkmcnt(15)
    v_mfma_f32_32x32x16_bf16 v[64:79], v[24:27], v[152:155], v[64:79]
    v_mfma_f32_32x32x16_bf16 v[80:95], v[28:31], v[152:155], v[80:95]
    ds_read_b64_tr_b16 v[24:25], v14 offset:6144
    ds_read_b64_tr_b16 v[26:27], v14 offset:7168
    ds_read_b64_tr_b16 v[28:29], v14 offset:6400
    ds_read_b64_tr_b16 v[30:31], v14 offset:7424
    s_waitcnt lgkmcnt(15)
    v_mfma_f32_32x32x16_bf16 v[64:79], v[32:35], v[156:159], v[64:79]
    v_mfma_f32_32x32x16_bf16 v[80:95], v[36:39], v[156:159], v[80:95]
    s_waitcnt vmcnt(8)
    s_barrier
    ds_read_b64_tr_b16 v[32:33], v12 offset:0
    ds_read_b64_tr_b16 v[34:35], v12 offset:1024
    ds_read_b64_tr_b16 v[36:37], v12 offset:256
    ds_read_b64_tr_b16 v[38:39], v12 offset:1280
    s_waitcnt lgkmcnt(15)
    s_waitcnt vmcnt(12)
    s_cmp_eq_u32 s26, 0
    s_cbranch_scc0 NFO_29
    v_mov_b32 v56, s56
    v_mov_b32 v57, 0
    s_mov_b64 s[58:59], exec
    s_mov_b64 exec, 1
    buffer_store_dword v56, v57, s[12:15], s60 offen sc0 sc1
    s_mov_b64 exec, s[58:59]
NFO_29:
    s_mov_b32 s61, 0
    v_mfma_f32_32x32x16_bf16 v[64:79], v[40:43], v[160:163], v[64:79]
    s_add_u32 m0, s33, 98304
    s_add_u32 s57, s30, 344064
    buffer_load_dwordx4 v5, s[8:11], s57 offen lds
    s_add_u32 m0, s33, 99328
    s_add_u32 s57, s30, 351232
    buffer_load_dwordx4 v5, s[8:11], s57 offen lds
    v_mfma_f32_32x32x16_bf16 v[80:95], v[44:47], v[160:163], v[80:95]
    s_add_u32 m0, s33, 100352
    s_add_u32 s57, s30, 358400
    buffer_load_dwordx4 v5, s[8:11], s57 offen lds
    s_add_u32 m0, s33, 101376
    s_add_u32 s57, s30, 365568
    buffer_load_dwordx4 v5, s[8:11], s57 offen lds
    ds_read_b64_tr_b16 v[40:41], v12 offset:2048
    ds_read_b64_tr_b16 v[42:43], v12 offset:3072
    ds_read_b64_tr_b16 v[44:45], v12 offset:2304
    ds_read_b64_tr_b16 v[46:47], v12 offset:3328
    s_waitcnt lgkmcnt(15)
    v_mfma_f32_32x32x16_bf16 v[64:79], v[48:51], v[164:167], v[64:79]
    v_mfma_f32_32x32x16_bf16 v[80:95], v[52:55], v[164:167], v[80:95]
    ds_read_b64_tr_b16 v[48:49], v12 offset:4096
    ds_read_b64_tr_b16 v[50:51], v12 offset:5120
    ds_read_b64_tr_b16 v[52:53], v12 offset:4352
    ds_read_b64_tr_b16 v[54:55], v12 offset:5376
    s_waitcnt lgkmcnt(15)
    v_mfma_f32_32x32x16_bf16 v[64:79], v[16:19], v[168:171], v[64:79]
    buffer_load_dword v60, v9, s[12:15], 0 offen sc0 sc1
    v_mfma_f32_32x32x16_bf16 v[80:95], v[20:23], v[168:171], v[80:95]
    ds_read_b64_tr_b16 v[16:17], v12 offset:6144
    ds_read_b64_tr_b16 v[18:19], v12 offset:7168
    ds_read_b64_tr_b16 v[20:21], v12 offset:6400
    ds_read_b64_tr_b16 v[22:23], v12 offset:7424
    s_waitcnt lgkmcnt(15)
    v_mfma_f32_32x32x16_bf16 v[64:79], v[24:27], v[172:175], v[64:79]
    v_mfma_f32_32x32x16_bf16 v[80:95], v[28:31], v[172:175], v[80:95]
    s_waitcnt vmcnt(9)
    s_barrier
    ds_read_b64_tr_b16 v[24:25], v12 offset:32768
    ds_read_b64_tr_b16 v[26:27], v12 offset:33792
    ds_read_b64_tr_b16 v[28:29], v12 offset:33024
    ds_read_b64_tr_b16 v[30:31], v12 offset:34048
    s_waitcnt lgkmcnt(15)
    v_mfma_f32_32x32x16_bf16 v[64:79], v[32:35], v[176:179], v[64:79]
    s_add_u32 m0, s33, 131072
    s_add_u32 s57, s32, 0
    buffer_load_dwordx4 v5, s[16:19], s57 offen lds
    s_add_u32 m0, s33, 132096
    s_add_u32 s57, s32, 7168
    buffer_load_dwordx4 v5, s[16:19], s57 offen lds
    v_mfma_f32_32x32x16_bf16 v[80:95], v[36:39], v[176:179], v[80:95]
    s_add_u32 m0, s33, 133120
    s_add_u32 s57, s32, 14336
    buffer_load_dwordx4 v5, s[16:19], s57 offen lds
    s_add_u32 m0, s33, 134144
    s_add_u32 s57, s32, 21504
    buffer_load_dwordx4 v5, s[16:19], s57 offen lds
    ds_read_b64_tr_b16 v[32:33], v12 offset:34816
    ds_read_b64_tr_b16 v[34:35], v12 offset:35840
    ds_read_b64_tr_b16 v[36:37], v12 offset:35072
    ds_read_b64_tr_b16 v[38:39], v12 offset:36096
    s_waitcnt lgkmcnt(15)
    v_mfma_f32_32x32x16_bf16 v[64:79], v[40:43], v[180:183], v[64:79]
    buffer_load_dword v61, v9, s[12:15], 0 offen sc0 sc1
    v_mfma_f32_32x32x16_bf16 v[80:95], v[44:47], v[180:183], v[80:95]
    ds_read_b64_tr_b16 v[40:41], v12 offset:36864
    ds_read_b64_tr_b16 v[42:43], v12 offset:37888
    ds_read_b64_tr_b16 v[44:45], v12 offset:37120
    ds_read_b64_tr_b16 v[46:47], v12 offset:38144
    s_waitcnt lgkmcnt(15)
    v_mfma_f32_32x32x16_bf16 v[64:79], v[48:51], v[184:187], v[64:79]
    v_mfma_f32_32x32x16_bf16 v[80:95], v[52:55], v[184:187], v[80:95]
    ds_read_b64_tr_b16 v[48:49], v12 offset:38912
    ds_read_b64_tr_b16 v[50:51], v12 offset:39936
    ds_read_b64_tr_b16 v[52:53], v12 offset:39168
    ds_read_b64_tr_b16 v[54:55], v12 offset:40192
    s_waitcnt lgkmcnt(15)
    v_mfma_f32_32x32x16_bf16 v[64:79], v[16:19], v[188:191], v[64:79]
    v_mfma_f32_32x32x16_bf16 v[80:95], v[20:23], v[188:191], v[80:95]
    s_waitcnt vmcnt(10)
    s_barrier
    ds_read_b64_tr_b16 v[16:17], v13 offset:0
    ds_read_b64_tr_b16 v[18:19], v13 offset:1024
    ds_read_b64_tr_b16 v[20:21], v13 offset:256
    ds_read_b64_tr_b16 v[22:23], v13 offset:1280
    s_waitcnt lgkmcnt(15)
    v_mfma_f32_32x32x16_bf16 v[64:79], v[24:27], v[192:195], v[64:79]
    s_add_u32 m0, s33, 0
    s_add_u32 s57, s32, 50176
    buffer_load_dwordx4 v5, s[16:19], s57 offen lds
    s_add_u32 m0, s33, 1024
    s_add_u32 s57, s32, 57344
    buffer_load_dwordx4 v5, s[16:19], s57 offen lds
    s_add_u32 m0, s33, 2048
    s_add_u32 s57, s32, 64512
    buffer_load_dwordx4 v5, s[16:19], s57 offen lds
    v_mfma_f32_32x32x16_bf16 v[80:95], v[28:31], v[192:195], v[80:95]
    s_add_u32 m0, s33, 3072
    s_add_u32 s57, s32, 71680
    buffer_load_dwordx4 v5, s[16:19], s57 offen lds
    buffer_load_dword v62, v9, s[12:15], 0 offen sc0 sc1
    ds_read_b64_tr_b16 v[24:25], v13 offset:2048
    ds_read_b64_tr_b16 v[26:27], v13 offset:3072
    ds_read_b64_tr_b16 v[28:29], v13 offset:2304
    ds_read_b64_tr_b16 v[30:31], v13 offset:3328
    s_waitcnt lgkmcnt(15)
    v_mfma_f32_32x32x16_bf16 v[64:79], v[32:35], v[196:199], v[64:79]
    v_mfma_f32_32x32x16_bf16 v[80:95], v[36:39], v[196:199], v[80:95]
    ds_read_b64_tr_b16 v[32:33], v13 offset:4096
    ds_read_b64_tr_b16 v[34:35], v13 offset:5120
    ds_read_b64_tr_b16 v[36:37], v13 offset:4352
    ds_read_b64_tr_b16 v[38:39], v13 offset:5376
    s_waitcnt lgkmcnt(15)
    v_mfma_f32_32x32x16_bf16 v[64:79], v[40:43], v[200:203], v[64:79]
    v_mfma_f32_32x32x16_bf16 v[80:95], v[44:47], v[200:203], v[80:95]
    ds_read_b64_tr_b16 v[40:41], v13 offset:6144
    ds_read_b64_tr_b16 v[42:43], v13 offset:7168
    ds_read_b64_tr_b16 v[44:45], v13 offset:6400
    ds_read_b64_tr_b16 v[46:47], v13 offset:7424
    s_waitcnt lgkmcnt(15)
    s_cmp_eq_u32 s61, 0
    s_cbranch_scc0 FOS_30
    s_waitcnt vmcnt(10)
    v_cmp_ne_u32 vcc, s56, v60
    s_nop 1
    s_cmp_eq_u64 vcc, 0
    s_cbranch_scc0 FOS_30
    s_add_u32 s57, s29, 0
    buffer_load_dwordx4 v[96:99], v6, s[12:15], s57 offen sc1
    s_add_u32 s57, s29, 1024
    buffer_load_dwordx4 v[100:103], v6, s[12:15], s57 offen sc1
    s_add_u32 s57, s29, 2048
    buffer_load_dwordx4 v[104:107], v6, s[12:15], s57 offen sc1
    s_add_u32 s57, s29, 3072
    buffer_load_dwordx4 v[108:111], v6, s[12:15], s57 offen sc1
    s_add_u32 s57, s29, 4096
    buffer_load_dwordx4 v[112:115], v6, s[12:15], s57 offen sc1
    s_add_u32 s57, s29, 5120
    buffer_load_dwordx4 v[116:119], v6, s[12:15], s57 offen sc1
    s_add_u32 s57, s29, 6144
    buffer_load_dwordx4 v[120:123], v6, s[12:15], s57 offen sc1
    s_add_u32 s57, s29, 7168
    buffer_load_dwordx4 v[124:127], v6, s[12:15], s57 offen sc1
    s_mov_b32 s61, 1
FOS_30:
    v_mfma_f32_32x32x16_bf16 v[64:79], v[48:51], v[204:207], v[64:79]
    v_mfma_f32_32x32x16_bf16 v[80:95], v[52:55], v[204:207], v[80:95]
    s_waitcnt vmcnt(11)
    s_barrier
    ds_read_b64_tr_b16 v[48:49], v13 offset:32768
    ds_read_b64_tr_b16 v[50:51], v13 offset:33792
    ds_read_b64_tr_b16 v[52:53], v13 offset:33024
    ds_read_b64_tr_b16 v[54:55], v13 offset:34048
    s_waitcnt lgkmcnt(15)
    v_mfma_f32_32x32x16_bf16 v[64:79], v[16:19], v[208:211], v[64:79]
    v_mfma_f32_32x32x16_bf16 v[80:95], v[20:23], v[208:211], v[80:95]
    ds_read_b64_tr_b16 v[16:17], v13 offset:34816
    ds_read_b64_tr_b16 v[18:19], v13 offset:35840
    ds_read_b64_tr_b16 v[20:21], v13 offset:35072
    ds_read_b64_tr_b16 v[22:23], v13 offset:36096
    s_waitcnt lgkmcnt(15)
    v_mfma_f32_32x32x16_bf16 v[64:79], v[24:27], v[212:215], v[64:79]
    v_mfma_f32_32x32x16_bf16 v[80:95], v[28:31], v[212:215], v[80:95]
    ds_read_b64_tr_b16 v[24:25], v13 offset:36864
    ds_read_b64_tr_b16 v[26:27], v13 offset:37888
    ds_read_b64_tr_b16 v[28:29], v13 offset:37120
    ds_read_b64_tr_b16 v[30:31], v13 offset:38144
    s_waitcnt lgkmcnt(15)
    s_cmp_eq_u32 s61, 0
    s_cbranch_scc0 FOS_31
    s_waitcnt vmcnt(5)
    v_cmp_ne_u32 vcc, s56, v61
    s_nop 1
    s_cmp_eq_u64 vcc, 0
    s_cbranch_scc0 FOS_31
    s_add_u32 s57, s29, 0
    buffer_load_dwordx4 v[96:99], v6, s[12:15], s57 offen sc1
    s_add_u32 s57, s29, 1024
    buffer_load_dwordx4 v[100:103], v6, s[12:15], s57 offen sc1
    s_add_u32 s57, s29, 2048
    buffer_load_dwordx4 v[104:107], v6, s[12:15], s57 offen sc1
    s_add_u32 s57, s29, 3072
    buffer_load_dwordx4 v[108:111], v6, s[12:15], s57 offen sc1
    s_add_u32 s57, s29, 4096
    buffer_load_dwordx4 v[112:115], v6, s[12:15], s57 offen sc1
    s_add_u32 s57, s29, 5120
    buffer_load_dwordx4 v[116:119], v6, s[12:15], s57 offen sc1
    s_add_u32 s57, s29, 6144
    buffer_load_dwordx4 v[120:123], v6, s[12:15], s57 offen sc1
    s_add_u32 s57, s29, 7168
    buffer_load_dwordx4 v[124:127], v6, s[12:15], s57 offen sc1
    s_mov_b32 s61, 1
FOS_31:
    v_mfma_f32_32x32x16_bf16 v[64:79], v[32:35], v[216:219], v[64:79]
    v_mfma_f32_32x32x16_bf16 v[80:95], v[36:39], v[216:219], v[80:95]
    ds_read_b64_tr_b16 v[32:33], v13 offset:38912
    ds_read_b64_tr_b16 v[34:35], v13 offset:39936
    ds_read_b64_tr_b16 v[36:37], v13 offset:39168
    ds_read_b64_tr_b16 v[38:39], v13 offset:40192
    s_waitcnt lgkmcnt(15)
    v_mfma_f32_32x32x16_bf16 v[64:79], v[40:43], v[220:223], v[64:79]
    v_mfma_f32_32x32x16_bf16 v[80:95], v[44:47], v[220:223], v[80:95]
    s_waitcnt vmcnt(6)
    s_barrier
    ds_read_b64_tr_b16 v[40:41], v14 offset:0
    ds_read_b64_tr_b16 v[42:43], v14 offset:1024
    ds_read_b64_tr_b16 v[44:45], v14 offset:256
    ds_read_b64_tr_b16 v[46:47], v14 offset:1280
    s_waitcnt lgkmcnt(15)
    v_mfma_f32_32x32x16_bf16 v[64:79], v[48:51], v[224:227], v[64:79]
    v_mfma_f32_32x32x16_bf16 v[80:95], v[52:55], v[224:227], v[80:95]
    ds_read_b64_tr_b16 v[48:49], v14 offset:2048
    ds_read_b64_tr_b16 v[50:51], v14 offset:3072
    ds_read_b64_tr_b16 v[52:53], v14 offset:2304
    ds_read_b64_tr_b16 v[54:55], v14 offset:3328
    s_waitcnt lgkmcnt(15)
    s_cmp_eq_u32 s61, 0
    s_cbranch_scc0 FOS_32
    s_waitcnt vmcnt(0)
    v_cmp_ne_u32 vcc, s56, v62
    s_nop 1
    s_cmp_eq_u64 vcc, 0
    s_cbranch_scc0 FOS_32
    s_add_u32 s57, s29, 0
    buffer_load_dwordx4 v[96:99], v6, s[12:15], s57 offen sc1
    s_add_u32 s57, s29, 1024
    buffer_load_dwordx4 v[100:103], v6, s[12:15], s57 offen sc1
    s_add_u32 s57, s29, 2048
    buffer_load_dwordx4 v[104:107], v6, s[12:15], s57 offen sc1
    s_add_u32 s57, s29, 3072
    buffer_load_dwordx4 v[108:111], v6, s[12:15], s57 offen sc1
    s_add_u32 s57, s29, 4096
    buffer_load_dwordx4 v[112:115], v6, s[12:15], s57 offen sc1
    s_add_u32 s57, s29, 5120
    buffer_load_dwordx4 v[116:119], v6, s[12:15], s57 offen sc1
    s_add_u32 s57, s29, 6144
    buffer_load_dwordx4 v[120:123], v6, s[12:15], s57 offen sc1
    s_add_u32 s57, s29, 7168
    buffer_load_dwordx4 v[124:127], v6, s[12:15], s57 offen sc1
    s_mov_b32 s61, 1
FOS_32:
    v_mfma_f32_32x32x16_bf16 v[64:79], v[16:19], v[228:231], v[64:79]
    v_mfma_f32_32x32x16_bf16 v[80:95], v[20:23], v[228:231], v[80:95]
    ds_read_b64_tr_b16 v[16:17], v14 offset:4096
    ds_read_b64_tr_b16 v[18:19], v14 offset:5120
    ds_read_b64_tr_b16 v[20:21], v14 offset:4352
    ds_read_b64_tr_b16 v[22:23], v14 offset:5376
    s_waitcnt lgkmcnt(15)
    v_mfma_f32_32x32x16_bf16 v[64:79], v[24:27], v[232:235], v[64:79]
    v_mfma_f32_32x32x16_bf16 v[80:95], v[28:31], v[232:235], v[80:95]
    ds_read_b64_tr_b16 v[24:25], v14 offset:6144
    ds_read_b64_tr_b16 v[26:27], v14 offset:7168
    ds_read_b64_tr_b16 v[28:29], v14 offset:6400
    ds_read_b64_tr_b16 v[30:31], v14 offset:7424
    s_waitcnt lgkmcnt(15)
    s_cmp_eq_u32 s61, 0
    s_cbranch_scc0 FOS_33
    s_mov_b32 s57, 0
POLL_34:
    buffer_load_dword v10, v9, s[12:15], 0 offen sc0 sc1
    s_waitcnt vmcnt(0)
POLLC_36:
    v_cmp_ne_u32 vcc, s56, v10
    s_nop 1
    s_cmp_eq_u64 vcc, 0
    s_cbranch_scc1 POLLD_35
    s_add_u32 s57, s57, 1
    s_cmp_gt_u32 s57, 0x40000
    s_cbranch_scc1 POLLD_35
    s_sleep 1
    s_branch POLL_34
POLLD_35:
    s_add_u32 s57, s29, 0
    buffer_load_dwordx4 v[96:99], v6, s[12:15], s57 offen sc1
    s_add_u32 s57, s29, 1024
    buffer_load_dwordx4 v[100:103], v6, s[12:15], s57 offen sc1
    s_add_u32 s57, s29, 2048
    buffer_load_dwordx4 v[104:107], v6, s[12:15], s57 offen sc1
    s_add_u32 s57, s29, 3072
    buffer_load_dwordx4 v[108:111], v6, s[12:15], s57 offen sc1
    s_add_u32 s57, s29, 4096
    buffer_load_dwordx4 v[112:115], v6, s[12:15], s57 offen sc1
    s_add_u32 s57, s29, 5120
    buffer_load_dwordx4 v[116:119], v6, s[12:15], s57 offen sc1
    s_add_u32 s57, s29, 6144
    buffer_load_dwordx4 v[120:123], v6, s[12:15], s57 offen sc1
    s_add_u32 s57, s29, 7168
    buffer_load_dwordx4 v[124:127], v6, s[12:15], s57 offen sc1
    s_mov_b32 s61, 1
FOS_33:
    v_mfma_f32_32x32x16_bf16 v[64:79], v[32:35], v[236:239], v[64:79]
    v_mfma_f32_32x32x16_bf16 v[80:95], v[36:39], v[236:239], v[80:95]
    s_waitcnt vmcnt(1)
    s_barrier
    ds_read_b64_tr_b16 v[32:33], v12 offset:0
    ds_read_b64_tr_b16 v[34:35], v12 offset:1024
    ds_read_b64_tr_b16 v[36:37], v12 offset:256
    ds_read_b64_tr_b16 v[38:39], v12 offset:1280
    s_waitcnt lgkmcnt(15)
    s_waitcnt vmcnt(0)
    v_mfma_f32_32x32x16_bf16 v[64:79], v[40:43], v[96:99], v[64:79]
    v_mfma_f32_32x32x16_bf16 v[80:95], v[44:47], v[96:99], v[80:95]
    ds_read_b64_tr_b16 v[40:41], v12 offset:2048
    ds_read_b64_tr_b16 v[42:43], v12 offset:3072
    ds_read_b64_tr_b16 v[44:45], v12 offset:2304
    ds_read_b64_tr_b16 v[46:47], v12 offset:3328
    s_waitcnt lgkmcnt(15)
    v_mfma_f32_32x32x16_bf16 v[64:79], v[48:51], v[100:103], v[64:79]
    v_mfma_f32_32x32x16_bf16 v[80:95], v[52:55], v[100:103], v[80:95]
    ds_read_b64_tr_b16 v[48:49], v12 offset:4096
    ds_read_b64_tr_b16 v[50:51], v12 offset:5120
    ds_read_b64_tr_b16 v[52:53], v12 offset:4352
    ds_read_b64_tr_b16 v[54:55], v12 offset:5376
    s_waitcnt lgkmcnt(15)
    v_mfma_f32_32x32x16_bf16 v[64:79], v[16:19], v[104:107], v[64:79]
    v_mfma_f32_32x32x16_bf16 v[80:95], v[20:23], v[104:107], v[80:95]
    ds_read_b64_tr_b16 v[16:17], v12 offset:6144
    ds_read_b64_tr_b16 v[18:19], v12 offset:7168
    ds_read_b64_tr_b16 v[20:21], v12 offset:6400
    ds_read_b64_tr_b16 v[22:23], v12 offset:7424
    s_waitcnt lgkmcnt(15)
    v_mfma_f32_32x32x16_bf16 v[64:79], v[24:27], v[108:111], v[64:79]
    v_mfma_f32_32x32x16_bf16 v[80:95], v[28:31], v[108:111], v[80:95]
    s_waitcnt lgkmcnt(12)
    v_mfma_f32_32x32x16_bf16 v[64:79], v[32:35], v[112:115], v[64:79]
    v_mfma_f32_32x32x16_bf16 v[80:95], v[36:39], v[112:115], v[80:95]
    s_waitcnt lgkmcnt(8)
    v_mfma_f32_32x32x16_bf16 v[64:79], v[40:43], v[116:119], v[64:79]
    v_mfma_f32_32x32x16_bf16 v[80:95], v[44:47], v[116:119], v[80:95]
    s_waitcnt lgkmcnt(4)
    v_mfma_f32_32x32x16_bf16 v[64:79], v[48:51], v[120:123], v[64:79]
    v_mfma_f32_32x32x16_bf16 v[80:95], v[52:55], v[120:123], v[80:95]
    s_waitcnt lgkmcnt(0)
    v_mfma_f32_32x32x16_bf16 v[64:79], v[16:19], v[124:127], v[64:79]
    v_mfma_f32_32x32x16_bf16 v[80:95], v[20:23], v[124:127], v[80:95]
    s_barrier
    s_lshl_b32 s57, s26, 15
    s_lshl_b32 s58, s22, 11
    s_add_u32 s57, s57, s58
    v_add_u32 v14, s57, v6
    s_cmp_eq_u32 s22, 0
    s_nop 3
    s_cbranch_scc1 SKW_37
    s_nop 3
    ds_write_b128 v14, v[64:67] offset:0
    ds_write_b128 v14, v[68:71] offset:1024
    s_branch SKX_38
SKW_37:
    v_mov_b32 v96, v64
    v_mov_b32 v97, v65
    v_mov_b32 v98, v66
    v_mov_b32 v99, v67
    v_mov_b32 v100, v68
    v_mov_b32 v101, v69
    v_mov_b32 v102, v70
    v_mov_b32 v103, v71
SKX_38:
    s_cmp_eq_u32 s22, 1
    s_cbranch_scc1 SKW_39
    ds_write_b128 v14, v[72:75] offset:8192
    ds_write_b128 v14, v[76:79] offset:9216
    s_branch SKX_40
SKW_39:
    v_mov_b32 v96, v72
    v_mov_b32 v97, v73
    v_mov_b32 v98, v74
    v_mov_b32 v99, v75
    v_mov_b32 v100, v76
    v_mov_b32 v101, v77
    v_mov_b32 v102, v78
    v_mov_b32 v103, v79
SKX_40:
    s_cmp_eq_u32 s22, 2
    s_cbranch_scc1 SKW_41
    ds_write_b128 v14, v[80:83] offset:16384
    ds_write_b128 v14, v[84:87] offset:17408
    s_branch SKX_42
SKW_41:
    v_mov_b32 v96, v80
    v_mov_b32 v97, v81
    v_mov_b32 v98, v82
    v_mov_b32 v99, v83
    v_mov_b32 v100, v84
    v_mov_b32 v101, v85
    v_mov_b32 v102, v86
    v_mov_b32 v103, v87
SKX_42:
    s_cmp_eq_u32 s22, 3
    s_cbranch_scc1 SKW_43
    ds_write_b128 v14, v[88:91] offset:24576
    ds_write_b128 v14, v[92:95] offset:25600
    s_branch SKX_44
SKW_43:
    v_mov_b32 v96, v88
    v_mov_b32 v97, v89
    v_mov_b32 v98, v90
    v_mov_b32 v99, v91
    v_mov_b32 v100, v92
    v_mov_b32 v101, v93
    v_mov_b32 v102, v94
    v_mov_b32 v103, v95
SKX_44:
    s_waitcnt lgkmcnt(0)
    s_barrier
    s_lshl_b32 s57, s26, 15
    s_lshl_b32 s58, s22, 13
    s_add_u32 s57, s57, s58
    v_add_u32 v14, s57, v6
    s_add_u32 s57, s22, 1
    s_and_b32 s57, s57, 3
    s_lshl_b32 s57, s57, 11
    v_add_u32 v15, s57, v14
    ds_read_b128 v[104:107], v15
    ds_read_b128 v[108:111], v15 offset:1024
    s_add_u32 s57, s22, 2
    s_and_b32 s57, s57, 3
    s_lshl_b32 s57, s57, 11
    v_add_u32 v15, s57, v14
    ds_read_b128 v[112:115], v15
    ds_read_b128 v[116:119], v15 offset:1024
    s_add_u32 s57, s22, 3
    s_and_b32 s57, s57, 3
    s_lshl_b32 s57, s57, 11
    v_add_u32 v15, s57, v14
    ds_read_b128 v[120:123], v15
    ds_read_b128 v[124:127], v15 offset:1024
    s_waitcnt vmcnt(0) lgkmcnt(0)
    v_add_f32 v96, v96, v104
    v_add_f32 v112, v112, v120
    v_add_f32 v97, v97, v105
    v_add_f32 v113, v113, v121
    v_add_f32 v98, v98, v106
    v_add_f32 v114, v114, v122
    v_add_f32 v99, v99, v107
    v_add_f32 v115, v115, v123
    v_add_f32 v100, v100, v108
    v_add_f32 v116, v116, v124
    v_add_f32 v101, v101, v109
    v_add_f32 v117, v117, v125
    v_add_f32 v102, v102, v110
    v_add_f32 v118, v118, v126
    v_add_f32 v103, v103, v111
    v_add_f32 v119, v119, v127
    v_add_f32 v96, v96, v112
    v_add_f32 v97, v97, v113
    v_add_f32 v98, v98, v114
    v_add_f32 v99, v99, v115
    v_add_f32 v100, v100, v116
    v_add_f32 v101, v101, v117
    v_add_f32 v102, v102, v118
    v_add_f32 v103, v103, v119
    v_lshlrev_b32 v15, 16, v240
    v_add_f32 v96, v96, v15
    v_and_b32 v15, 0xffff0000, v240
    v_add_f32 v97, v97, v15
    v_lshlrev_b32 v15, 16, v244
    v_add_f32 v96, v96, v15
    v_and_b32 v15, 0xffff0000, v244
    v_add_f32 v97, v97, v15
    v_lshlrev_b32 v15, 16, v241
    v_add_f32 v98, v98, v15
    v_and_b32 v15, 0xffff0000, v241
    v_add_f32 v99, v99, v15
    v_lshlrev_b32 v15, 16, v245
    v_add_f32 v98, v98, v15
    v_and_b32 v15, 0xffff0000, v245
    v_add_f32 v99, v99, v15
    v_lshlrev_b32 v15, 16, v242
    v_add_f32 v100, v100, v15
    v_and_b32 v15, 0xffff0000, v242
    v_add_f32 v101, v101, v15
    v_lshlrev_b32 v15, 16, v246
    v_add_f32 v100, v100, v15
    v_and_b32 v15, 0xffff0000, v246
    v_add_f32 v101, v101, v15
    v_lshlrev_b32 v15, 16, v243
    v_add_f32 v102, v102, v15
    v_and_b32 v15, 0xffff0000, v243
    v_add_f32 v103, v103, v15
    v_lshlrev_b32 v15, 16, v247
    v_add_f32 v102, v102, v15
    v_and_b32 v15, 0xffff0000, v247
    v_add_f32 v103, v103, v15
    v_cvt_pk_bf16_f32 v20, v96, v97
    v_cvt_pk_bf16_f32 v21, v98, v99
    v_cvt_pk_bf16_f32 v22, v100, v101
    v_cvt_pk_bf16_f32 v23, v102, v103
    buffer_store_dwordx2 v[20:21], v11, s[84:87], 0 offen
    buffer_store_dwordx2 v[22:23], v11, s[84:87], 0 offen offset:16
    s_or_b32 s57, s2, s3
    s_cmp_eq_u32 s57, 0
    s_cbranch_scc0 NEP_45
    s_mov_b32 s60, 17334272
    v_mov_b32 v40, s56
    v_mov_b32 v41, 0
    s_mov_b64 s[58:59], exec
    s_mov_b64 exec, 1
    buffer_store_dword v40, v41, s[12:15], s60 offen sc0 sc1
    s_mov_b64 exec, s[58:59]
NEP_45:
K_END:
    s_endpgm
CODE_END:
    s_endpgm
.section .rodata,"a"
.p2align 6
.amdhsa_kernel parallel_sum__mha_block__dense_activation_gelu__prompt_kernel
  .amdhsa_next_free_vgpr 248
  .amdhsa_next_free_sgpr 102
  .amdhsa_accum_offset 248
  .amdhsa_group_segment_fixed_size 0
  .amdhsa_kernarg_size 88
  .amdhsa_user_sgpr_count 2
  .amdhsa_user_sgpr_kernarg_segment_ptr 1
  .amdhsa_system_sgpr_workgroup_id_x 1
  .amdhsa_float_denorm_mode_32 3
.end_amdhsa_kernel
```
